```python
import torch

def _softmax(x, axis=-1):
    return torch.softmax(x, dim=axis)
def _gelu(x):
    return torch.nn.functional.gelu(x, approximate="tanh")
def _silu(x):
    return torch.nn.functional.silu(x)
def _sigmoid(x):
    return torch.sigmoid(x)
def _layernorm(x, axis=-1, eps=1e-5):
    m = x.mean(dim=axis, keepdim=True)
    v = x.var(dim=axis, keepdim=True, unbiased=False)
    return (x - m) / torch.sqrt(v + eps)
def _scatter_add(tgt, idx, src, axis=0):
    return tgt.clone().index_add_(axis, idx, src)
def _segment_sum(src, seg, n):
    out = torch.zeros((n,) + src.shape[1:], dtype=src.dtype)
    return out.index_add_(0, seg, src)
def _pad(x, pw):
    flat = tuple(v for pair in reversed(pw) for v in pair)
    return torch.nn.functional.pad(x, flat)

kernel_name = 'sequential_preLN__linear_kernel_hedgehog__dense_activation_squared_relu__prompt'

def setup_inputs():

    _w = (lambda a: (lambda t: t.to(torch.bfloat16) if t.is_floating_point() else t)(torch.as_tensor(a)))
    def _A_setup():
        B, S, D, H = 1, 2048, 640, 32
        Dh = D // H
        return {
            "x": _w((lambda *s: torch.randn(*s, dtype=torch.bfloat16) * 0.05)(B, S, D)),
            "wqkv": _w((lambda *s: torch.randn(*s, dtype=torch.bfloat16) * 0.2)(D, 3 * D)),
            "w_phi": _w((lambda *s: torch.randn(*s, dtype=torch.bfloat16) * 0.2)(H, Dh, Dh) * (Dh ** -0.5)),
            "wo": _w((lambda *s: torch.randn(*s, dtype=torch.bfloat16) * 0.05)(D, D)),
        }
    _A_in = _A_setup()

    def _B_setup():
        B, S, D, F = 1, 2048, 640, 1728
        return {
            "x": _w((lambda *s: torch.randn(*s, dtype=torch.bfloat16) * 0.05)(B, S, D)),
            "w1": _w((lambda *s: torch.randn(*s, dtype=torch.bfloat16) * 0.05)(D, F)),
            "b1": _w((lambda *s: torch.randn(*s, dtype=torch.bfloat16) * 0.4)(F)),
            "w2": _w((lambda *s: torch.randn(*s, dtype=torch.bfloat16) * 0.05)(F, D)),
            "b2": _w((lambda *s: torch.randn(*s, dtype=torch.bfloat16) * 1.6)(D)),
        }
    _B_in = _B_setup()

    return {
        "A_x": _A_in["x"],
        "A_wqkv": _A_in["wqkv"],
        "A_w_phi": _A_in["w_phi"],
        "A_wo": _A_in["wo"],
        "B_x": _B_in["x"],
        "B_w1": _B_in["w1"],
        "B_b1": _B_in["b1"],
        "B_w2": _B_in["w2"],
        "B_b2": _B_in["b2"],
    }

def reference(A_x, A_wqkv, A_w_phi, A_wo, B_x, B_w1, B_b1, B_w2, B_b2):
    def _A_ref(x, wqkv, w_phi, wo):
        B, S, D = x.shape
        H = 32; Dh = D // H
        qkv = (lambda x, *d: x.permute(*d))((x @ wqkv).reshape(B, S, 3, H, Dh), 2, 0, 3, 1, 4)
        q, k, v = qkv[0], qkv[1], qkv[2]
        pq = torch.einsum("bhsd,hdf->bhsf", q, w_phi)
        pk = torch.einsum("bhsd,hdf->bhsf", k, w_phi)
        phi_q = torch.concatenate([_softmax(pq, axis=-1), _softmax(-pq, axis=-1)], axis=-1)
        phi_k = torch.concatenate([_softmax(pk, axis=-1), _softmax(-pk, axis=-1)], axis=-1)
        kv = torch.einsum("bhsf,bhsd->bhfd", phi_k, v)
        z  = torch.einsum("bhsf->bhf", phi_k)
        num = torch.einsum("bhqf,bhfd->bhqd", phi_q, kv)
        den = torch.einsum("bhqf,bhf->bhq", phi_q, z)[..., None] + 1e-6
        o = num / den
        return (lambda x, *d: x.permute(*d))(o, 0, 2, 1, 3).reshape(B, S, D) @ wo

    def _B_ref(x, w1, b1, w2, b2):
        h = torch.einsum("bsd,df->bsf", x, w1) + b1
        zero = torch.zeros_like(h)
        r = torch.where(h > zero, h, zero)
        h = r * r
        out = torch.einsum("bsf,fd->bsd", h, w2) + b2
        return out

    x = A_x
    h = x + _A_ref(_layernorm(x, axis=-1), A_wqkv, A_w_phi, A_wo)
    h2 = h + _B_ref(_layernorm(h, axis=-1), B_w1, B_b1, B_w2, B_b2)
    return h2
```

```asm
; @launch grid=(256,1,1) block=(256,1,1) lds=163840
.amdgcn_target "amdgcn-amd-amdhsa--gfx950"
.text
.globl sequential_preLN__linear_kernel_hedgehog__dense_activation_squared_relu__prompt_kernel
.p2align 8
.type sequential_preLN__linear_kernel_hedgehog__dense_activation_squared_relu__prompt_kernel,@function
sequential_preLN__linear_kernel_hedgehog__dense_activation_squared_relu__prompt_kernel:
    s_cmp_ge_u32 s2, 256
    s_cbranch_scc1 L_end
    s_load_dwordx16 s[16:31], s[0:1], 0
    s_load_dwordx8 s[32:39], s[0:1], 64
    v_lshrrev_b32 v7, 6, v0
    v_and_b32 v1, 63, v0
    v_readfirstlane_b32 s3, v7
    v_lshlrev_b32 v2, 4, v1
    v_lshlrev_b32 v3, 3, v1
    v_mov_b32 v4, 1
    v_mov_b32 v5, 0
    s_cmp_lg_u32 s3, 2
    s_cbranch_scc1 L_nopf_1
    s_getpc_b64 s[56:57]
L_pc_2:
    s_and_b32 s56, s56, 0xffffff00
    s_mov_b32 s58, L_end-L_pc_2
    s_mov_b32 s59, 0x20000
    s_lshr_b32 s10, s2, 3
    s_lshl_b32 s10, s10, 11
    v_lshlrev_b32 v6, 5, v1
    v_add_u32 v6, s10, v6
    buffer_load_dword v6, v6, s[56:59], 0 offen
L_nopf_1:
    s_and_b32 s10, s2, 7
    s_lshr_b32 s11, s2, 3
    s_lshr_b32 s12, s10, 2
    s_lshl_b32 s10, s10, 1
    s_and_b32 s10, s10, 6
    s_or_b32 s10, s10, s12
    s_and_b32 s5, s10, 1
    s_lshl_b32 s5, s5, 3
    s_and_b32 s12, s11, 7
    s_add_u32 s5, s5, s12
    s_lshr_b32 s4, s10, 1
    s_lshl_b32 s4, s4, 2
    s_lshr_b32 s13, s11, 3
    s_add_u32 s4, s4, s13
    s_lshr_b32 s6, s10, 1
    s_lshl_b32 s6, s6, 3
    s_add_u32 s6, s6, s12
    s_and_b32 s7, s10, 1
    s_lshl_b32 s7, s7, 2
    s_add_u32 s7, s7, s13
    s_mov_b32 s8, s4
    s_mov_b32 s9, s5
    s_mov_b32 s42, 2621440
    s_mov_b32 s43, 0x20000
    s_mov_b32 s46, 2457600
    s_mov_b32 s47, 0x20000
    s_mov_b32 s50, 268435456
    s_mov_b32 s51, 0x20000
    s_mov_b32 s54, 25600
    s_mov_b32 s55, 0x20000
    v_lshrrev_b32 v7, 5, v0
    v_and_b32_e64 v8, 31, v0
    v_mul_u32_u24 v7, 1280, v7
    v_lshl_add_u32 v11, v8, 4, v7
    v_mov_b32 v9, 1073741824
    v_cmp_gt_u32 vcc, 16, v8
    s_lshl_b32 s68, s4, 4
    s_add_u32 s68, s68, s5
    s_mul_i32 s67, s68, 10240
    v_cndmask_b32 v12, v9, v11, vcc
    v_and_b32 v9, 15, v0
    v_min_u32 v9, 14, v9
    v_mul_u32_u24 v10, 13, v9
    v_lshrrev_b32_e64 v10, 6, v10
    v_mul_u32_u24 v10, 1200, v10
    v_lshl_add_u32 v10, v9, 4, v10
    v_lshrrev_b32_e64 v9, 4, v0
    v_mul_u32_u24 v9, 3840, v9
    v_add_u32 v13, v9, v10
    s_mul_i32 s65, s4, 153600
    s_mul_i32 s14, s5, 80
    s_add_u32 s65, s65, s14
    s_lshl_b32 s15, s3, 10
    s_mul_i32 s14, s5, 1600
    s_add_u32 s14, s14, s15
    s_sub_u32 s14, s14, 2048
    v_add_u32 v14, s14, v2
    s_lshl_b32 s10, s2, 2
    s_add_u32 s73, s10, s3
    s_waitcnt lgkmcnt(0)
    s_mov_b64 s[40:41], s[16:17]
    s_mov_b64 s[44:45], s[18:19]
    s_mov_b64 s[48:49], s[38:39]
    s_mov_b64 s[52:53], s[20:21]
    s_cmp_lg_u32 s73, 3
    s_cbranch_scc1 L_nozero_4
    v_lshlrev_b32 v10, 8, v1
    s_mov_b32 s10, 0x4000
    buffer_store_dword v5, v10, s[48:51], s10 offen sc1
    buffer_store_dword v5, v10, s[48:51], 0 offen sc1
L_nozero_4:
    s_mov_b32 s20, s67
    s_add_u32 m0, s15, 0
    s_nop 0
    buffer_load_dwordx4 v13, s[44:47], s65 offen nt lds
    s_add_u32 s65, s65, 61440
    s_add_u32 m0, s15, 4096
    s_nop 0
    buffer_load_dwordx4 v13, s[44:47], s65 offen nt lds
    s_add_u32 s65, s65, 61440
    s_cmp_ge_u32 s3, 2
    s_cbranch_scc1 L_phi_6
    s_add_u32 m0, s15, 8192
    s_nop 0
    buffer_load_dwordx4 v13, s[44:47], s65 offen nt lds
    s_branch L_phid_7
L_phi_6:
    s_add_u32 m0, s15, 10240
    s_nop 0
    buffer_load_dwordx4 v14, s[52:55], 0 offen lds
L_phid_7:
    buffer_load_dwordx4 v[244:247], v11, s[40:43], s20 offen
    buffer_load_dwordx4 v[248:251], v11, s[40:43], s20 offen offset:512
    buffer_load_dwordx4 v[252:255], v12, s[40:43], s20 offen offset:1024
    s_mov_b32 s56, s36
    s_mov_b32 s57, s37
    s_mov_b32 s58, 256
    s_mov_b32 s59, 0x20000
    s_cmp_lg_u32 s73, 3
    s_cbranch_scc1 L_noflag_10
    s_waitcnt vmcnt(6)
    buffer_store_dword v4, v5, s[56:59], 0 offen sc1
L_noflag_10:
    v_lshrrev_b32 v7, 3, v1
    v_mul_u32_u24 v7, 1280, v7
    v_lshrrev_b32 v8, 4, v1
    v_and_b32 v9, 7, v1
    v_xor_b32_e64 v8, v8, v9
    v_lshl_add_u32 v13, v8, 4, v7
    v_xor_b32_e64 v8, 4, v8
    v_lshl_add_u32 v14, v8, 4, v7
    v_add_u32 v14, 9216, v14
    v_add_u32 v15, 18432, v13
    v_add_u32 v16, 18432, v14
    s_lshl_b32 s64, s4, 2
    s_add_u32 s64, s64, s3
    s_mul_i32 s64, s64, 40960
    s_lshl_b32 s69, s3, 12
    s_mov_b32 s60, 0x3f803f80
    s_mov_b32 s61, 0x00003f80
    s_mov_b32 s62, 0x3f800000
    s_mov_b32 s63, 0x3fb8aa3b
    v_bfe_u32 v18, v1, 2, 2
    v_lshrrev_b32_e64 v20, 5, v1
    v_bfe_u32 v7, v1, 4, 1
    v_and_b32_e64 v8, 3, v1
    v_lshl_add_u32 v19, v7, 2, v8
    s_lshl_b32 s10, s3, 1
    v_add_u32 v7, s10, v7
    v_cmp_gt_u32 vcc, 5, v7
    v_and_b32 v9, 1, v8
    v_lshl_add_u32 v10, v7, 1, v9
    v_subrev_u32 v10, 10, v10
    v_min_u32 v10, 4, v10
    v_mul_u32_u24_e64 v9, 10, v9
    v_add3_u32 v9, v9, v7, 10
    v_cndmask_b32 v9, v10, v9, vcc
    v_lshrrev_b32 v8, 1, v8
    v_mul_u32_u24_e64 v8, 5, v8
    v_add_lshl_u32 v9, v9, v8, 3
    v_lshl_add_u32 v8, v20, 3, v18
    v_lshl_add_u32 v21, v8, 8, v9
    v_mov_b32 v8, 3072
    v_mov_b32 v9, 5120
    v_cndmask_b32_e64 v8, v8, v9, vcc
    v_add_u32 v9, 95, v7
    v_cndmask_b32 v7, v9, v7, vcc
    v_lshlrev_b32 v7, 10, v7
    v_and_b32_e64 v9, 15, v1
    v_lshl_add_u32 v7, v9, 4, v7
    s_mul_i32 s10, s4, 5
    v_add3_u32 v9, s10, v20, 0
    v_lshrrev_b32 v10, 2, v9
    v_and_b32_e64 v9, 3, v9
    v_mad_u32_u24 v10, v10, v8, v7
    v_lshl_add_u32 v23, v9, 8, v10
    v_add3_u32 v9, s10, v20, 2
    v_lshrrev_b32 v10, 2, v9
    v_and_b32 v9, 3, v9
    v_mad_u32_u24 v10, v10, v8, v7
    v_lshl_add_u32 v24, v9, 8, v10
    v_add3_u32 v9, s10, v20, 4
    v_lshrrev_b32 v10, 2, v9
    v_and_b32 v9, 3, v9
    v_mad_u32_u24 v10, v10, v8, v7
    v_lshl_add_u32 v25, v9, 8, v10
    v_mov_b32 v9, 1073741824
    v_cmp_gt_u32 vcc, 32, v1
    v_lshlrev_b32 v10, 2, v1
    s_nop 0
    v_cndmask_b32 v25, v9, v25, vcc
    v_cndmask_b32 v22, v9, v10, vcc
    s_mul_i32 s16, s5, 163840
    s_add_u32 s16, s16, 327680
    s_lshl_b32 s67, s5, 4
    s_add_u32 s67, s67, s4
    s_lshl_b32 s67, s67, 2
    s_add_u32 s67, s67, s3
    s_lshl_b32 s67, s67, 7
    s_add_u32 s67, s67, 196608
    s_lshl_b32 s68, s68, 9
    s_add_u32 s68, s68, 65536
    s_lshr_b32 s10, s3, 1
    s_lshl_b32 s10, s10, 7
    v_lshlrev_b32_e64 v7, 1, v20
    v_lshl_add_u32 v7, v18, 2, v7
    v_add_u32_e64 v7, s10, v7
    v_mul_u32_u24 v7, 144, v7
    v_add_u32 v7, 40960, v7
    v_min_u32_e64 v8, 5, v19
    v_lshl_add_u32 v34, v8, 3, v7
    v_lshrrev_b32_e64 v8, 2, v19
    v_add_lshl_u32 v8, v8, v19, 3
    v_and_b32 v9, 2, v19
    v_mul_u32_u24 v9, 20, v9
    v_add_u32 v9, 32, v9
    s_bitcmp1_b32 s3, 0
    s_cselect_b64 vcc, -1, 0
    s_cselect_b32 s11, 63, 31
    s_cselect_b32 s14, 4, 0
    v_cndmask_b32 v8, v8, v9, vcc
    v_add3_u32 v33, v7, v8, 48
    s_lshr_b32 s10, s3, 1
    s_mul_i32 s10, s10, 5
    s_add_u32 s10, s10, s14
    v_add_u32 v7, s10, v20
    v_mul_u32_u24 v7, 24, v7
    v_and_b32 v8, 31, v1
    v_add_lshl_u32 v7, v7, v8, 4
    v_mov_b32 v9, 1073741824
    v_cndmask_b32 v36, v7, v9, vcc
    v_and_b32 v8, s11, v1
    v_cmp_gt_u32 vcc, 24, v8
    s_nop 1
    v_cndmask_b32 v35, v9, v7, vcc
    v_cndmask_b32 v36, v9, v36, vcc
    s_lshl_b32 s10, s4, 2
    s_add_u32 s10, s10, s3
    s_lshl_b32 s10, s10, 11
    s_add_u32 s10, s10, 65536
    v_and_b32_e64 v7, 15, v1
    v_lshl_add_u32 v28, v7, 6, s10
    v_lshlrev_b32_e64 v26, 8, v7
    v_add_u32 v27, 61440, v2
    v_add_u32 v31, 159744, v3
    s_lshl_b32 s10, s3, 9
    s_add_u32 s10, s10, 159744
    v_and_b32 v7, 48, v1
    v_add_u32 v29, s10, v3
    s_lshl_b32 s11, s3, 5
    v_add_u32 v30, s10, v7
    v_and_b32 v7, 31, v1
    v_lshl_add_u32 v7, v20, 7, v7
    s_lshr_b32 s10, s3, 1
    v_add_u32 v7, s11, v7
    v_mul_u32_u24 v32, 144, v7
    v_add_u32 v32, 40960, v32
    s_mov_b32 s52, s22
    s_mov_b32 s53, s23
    s_mov_b32 s54, 819200
    s_mov_b32 s55, 0x20000
    s_min_u32 s10, s2, 159
    s_and_b32 s11, s10, 1
    s_lshr_b32 s10, s10, 1
    s_mul_i32 s12, s10, 205
    s_lshr_b32 s12, s12, 10
    s_mul_i32 s13, s12, 5
    s_sub_u32 s10, s10, s13
    s_lshl_b32 s13, s10, 3
    s_cmp_ge_u32 s10, 2
    s_cselect_b32 s14, 4, 0
    s_add_u32 s13, s13, s14
    s_cmp_eq_u32 s10, 4
    s_cselect_b32 s13, 16, s13
    s_cselect_b32 s14, 16, 0
    s_cmp_ge_u32 s3, 2
    s_cselect_b32 s14, s14, 0
    s_add_u32 s13, s13, s14
    s_lshl_b32 s14, s3, 1
    s_add_u32 s13, s13, s14
    s_mul_i32 s14, s12, 40
    s_add_u32 s13, s13, s14
    s_mul_i32 s13, s13, 1280
    s_mul_i32 s14, s11, 640
    s_add_u32 s13, s13, s14
    s_cmp_lt_u32 s2, 160
    s_cselect_b32 s14, 0, 1073741824
    v_add_u32 v10, s14, v2
    s_mul_i32 s14, s3, 1312
    s_add_u32 m0, s14, 118784
    s_mov_b32 exec_hi, 0xff
    buffer_load_dwordx4 v10, s[52:55], s13 offen lds
    s_add_u32 m0, s14, 119440
    s_add_u32 s13, s13, 1280
    buffer_load_dwordx4 v10, s[52:55], s13 offen lds
    s_mov_b64 exec, -1
    s_lshl_b32 s11, s11, 2
    s_add_u32 s11, s11, s3
    s_mul_i32 s11, s11, 20
    s_add_u32 s11, s11, s10
    s_lshr_b32 s10, s12, 2
    s_mul_i32 s10, s10, 5
    s_add_u32 s11, s11, s10
    s_mul_i32 s19, s11, 5120
    s_and_b32 s12, s12, 3
    s_lshl_b32 s12, s12, 8
    s_add_u32 s19, s19, s12
    s_add_u32 s19, s19, 16646144
    s_add_u32 m0, s69, 49152
    s_add_u32 s75, s64, 0
    buffer_load_dwordx4 v13, s[40:43], s75 offen offset:0  lds
    buffer_load_dwordx4 v14, s[40:43], s75 offen offset:1024  lds
    buffer_load_dwordx4 v15, s[40:43], s75 offen offset:2048  lds
    buffer_load_dwordx4 v16, s[40:43], s75 offen offset:3072  lds
    s_waitcnt vmcnt(9)
    s_barrier
    ds_read_b64_tr_b16 v[232:233], v21 offset:0
    ds_read_b64_tr_b16 v[234:235], v21 offset:1024
    ds_read_b64_tr_b16 v[236:237], v21 offset:4096
    ds_read_b64_tr_b16 v[238:239], v21 offset:5120
    ds_read_b64_tr_b16 v[240:241], v21 offset:8192
    ds_read_b64_tr_b16 v[242:243], v21 offset:9216
    v_mov_b32 v7, 0
    s_waitcnt lgkmcnt(4)
    buffer_store_dwordx4 v[232:235], v23, s[48:51], s16 offen sc1
    v_dot2c_f32_bf16 v7, s60, v232
    v_dot2c_f32_bf16 v7, s60, v233
    v_dot2c_f32_bf16 v7, s60, v234
    v_dot2c_f32_bf16 v7, s60, v235
    s_waitcnt lgkmcnt(2)
    buffer_store_dwordx4 v[236:239], v24, s[48:51], s16 offen sc1
    v_dot2c_f32_bf16 v7, s60, v236
    v_dot2c_f32_bf16 v7, s60, v237
    v_dot2c_f32_bf16 v7, s60, v238
    v_dot2c_f32_bf16 v7, s60, v239
    s_waitcnt lgkmcnt(0)
    buffer_store_dwordx4 v[240:243], v25, s[48:51], s16 offen sc1
    s_mov_b32 exec_hi, 0
    v_dot2c_f32_bf16 v7, s60, v240
    v_dot2c_f32_bf16 v7, s60, v241
    v_dot2c_f32_bf16 v7, s60, v242
    v_dot2c_f32_bf16 v7, s60, v243
    s_mov_b64 exec, -1
    s_nop 1
    v_mov_b32 v8, v7
    s_nop 1
    v_permlane32_swap_b32 v8, v7
    v_add_f32 v7, v7, v8
    buffer_store_dword v7, v22, s[48:51], s67 offen sc1
    s_cmp_lg_u32 s3, 0
    s_cbranch_scc1 L_pi_12
    buffer_load_dword v6, v5, s[56:59], 0 offen sc1
L_pi_12:
    s_add_u32 m0, s69, 65536
    s_add_u32 s75, s64, 128
    buffer_load_dwordx4 v13, s[40:43], s75 offen offset:0  lds
    buffer_load_dwordx4 v14, s[40:43], s75 offen offset:1024  lds
    buffer_load_dwordx4 v15, s[40:43], s75 offen offset:2048  lds
    buffer_load_dwordx4 v16, s[40:43], s75 offen offset:3072  lds
    s_add_u32 m0, s69, 81920
    s_add_u32 s75, s64, 256
    buffer_load_dwordx4 v13, s[40:43], s75 offen offset:0  lds
    buffer_load_dwordx4 v14, s[40:43], s75 offen offset:1024  lds
    buffer_load_dwordx4 v15, s[40:43], s75 offen offset:2048  lds
    buffer_load_dwordx4 v16, s[40:43], s75 offen offset:3072  lds
    v_mov_b32 v44, 0
    v_mov_b32_e64 v45, 0
    s_waitcnt vmcnt(20)
    v_dot2c_f32_bf16 v44, s60, v244
    v_dot2c_f32_bf16 v45, v244, v244
    v_dot2c_f32_bf16 v44, s60, v245
    v_dot2c_f32_bf16 v45, v245, v245
    v_dot2c_f32_bf16 v44, s60, v246
    v_dot2c_f32_bf16 v45, v246, v246
    v_dot2c_f32_bf16 v44, s60, v247
    v_dot2c_f32_bf16 v45, v247, v247
    s_waitcnt vmcnt(19)
    v_dot2c_f32_bf16 v44, s60, v248
    v_dot2c_f32_bf16 v45, v248, v248
    v_dot2c_f32_bf16 v44, s60, v249
    v_dot2c_f32_bf16 v45, v249, v249
    v_dot2c_f32_bf16 v44, s60, v250
    v_dot2c_f32_bf16 v45, v250, v250
    v_dot2c_f32_bf16 v44, s60, v251
    v_dot2c_f32_bf16 v45, v251, v251
    s_waitcnt vmcnt(18)
    v_dot2c_f32_bf16 v44, s60, v252
    v_dot2c_f32_bf16 v45, v252, v252
    v_dot2c_f32_bf16 v44, s60, v253
    v_dot2c_f32_bf16 v45, v253, v253
    v_dot2c_f32_bf16 v44, s60, v254
    v_dot2c_f32_bf16 v45, v254, v254
    v_dot2c_f32_bf16 v44, s60, v255
    v_dot2c_f32_bf16 v45, v255, v255
    s_nop 1
    v_add_f32_dpp v44, v44, v44 row_ror:1 row_mask:0xf bank_mask:0xf
    v_add_f32_dpp v45, v45, v45 row_ror:1 row_mask:0xf bank_mask:0xf
    s_nop 0
    v_add_f32_dpp v44, v44, v44 row_ror:2 row_mask:0xf bank_mask:0xf
    v_add_f32_dpp v45, v45, v45 row_ror:2 row_mask:0xf bank_mask:0xf
    s_nop 0
    v_add_f32_dpp v44, v44, v44 row_ror:4 row_mask:0xf bank_mask:0xf
    v_add_f32_dpp v45, v45, v45 row_ror:4 row_mask:0xf bank_mask:0xf
    s_nop 0
    v_add_f32_dpp v44, v44, v44 row_ror:8 row_mask:0xf bank_mask:0xf
    v_add_f32_dpp v45, v45, v45 row_ror:8 row_mask:0xf bank_mask:0xf
    v_mov_b32 v7, v44
    v_mov_b32 v8, v45
    s_nop 0
    v_permlane16_swap_b32 v7, v44
    v_permlane16_swap_b32 v8, v45
    v_add_f32 v44, v44, v7
    v_add_f32 v45, v45, v8
    v_mul_f32 v44, 0x3acccccd, v44
    v_mul_f32 v45, 0x3acccccd, v45
    v_fma_f32 v45, -v44, v44, v45
    v_max_f32_e64 v45, 0, v45
    v_add_f32 v45, 0x3727c5ac, v45
    v_rsq_f32 v244, v45
    s_nop 0
    v_mul_f32_e64 v245, -v44, v244
    v_and_b32 v7, 0xe0, v0
    v_and_b32 v8, 7, v0
    v_lshlrev_b32 v8, 3, v8
    v_lshl_add_u32 v7, v7, 1, v8
    s_mov_b32 exec_lo, 0xff
    s_mov_b32 exec_hi, 0xff
    buffer_store_dwordx2 v[244:245], v7, s[48:51], s68 offen sc1
    s_mov_b64 exec, -1
    v_and_b32 v7, 1, v19
    v_mul_u32_u24 v7, 800, v7
    v_mul_u32_u24 v8, 40, v18
    v_add_u32 v7, v7, v8
    v_lshrrev_b32_e64 v8, 1, v19
    v_lshl_add_u32 v9, v8, 3, v7
    v_add_u32 v10, 32, v7
    ds_read_b64_tr_b16 a[0:1], v9 offset:12288
    ds_read_b64_tr_b16 a[2:3], v9 offset:12448
    ds_read_b64_tr_b16 a[4:5], v9 offset:12608
    ds_read_b64_tr_b16 a[6:7], v9 offset:12768
    ds_read_b64_tr_b16 a[8:9], v9 offset:12928
    ds_read_b64_tr_b16 a[12:13], v10 offset:12288
    ds_read_b64_tr_b16 a[14:15], v10 offset:12448
    ds_read_b64_tr_b16 a[16:17], v10 offset:12608
    ds_read_b64_tr_b16 a[18:19], v10 offset:12768
    ds_read_b64_tr_b16 a[20:21], v10 offset:12928
    s_waitcnt vmcnt(9)
    s_cmp_lg_u32 s3, 0
    s_cbranch_scc1 L_ok_14
    v_cmp_gt_u32 vcc, 1, v6
    s_cbranch_vccz L_ok_14
    s_mov_b32 s70, 0
L_spin_15:
    buffer_load_dword v6, v5, s[56:59], 0 offen sc1
    s_add_u32 s70, s70, 1
    s_waitcnt vmcnt(0)
    v_cmp_gt_u32 vcc, 1, v6
    s_cmp_lt_u32 s70, 65536
    s_cselect_b64 vcc, vcc, 0
    s_cbranch_vccnz L_spin_15
L_ok_14:
    s_barrier
    s_cmp_lg_u32 s3, 0
    s_cbranch_scc1 L_sig_17
    s_mov_b64 exec, 1
    s_add_u32 s10, s5, 0
    s_lshl_b32 s10, s10, 8
    buffer_atomic_add v4, v5, s[48:51], s10 offen sc1
    s_mov_b64 exec, -1
L_sig_17:
    s_nop 0
    v_accvgpr_write_b32 a10, 0
    s_add_u32 m0, s69, 98304
    s_add_u32 s75, s64, 384
    buffer_load_dwordx4 v13, s[40:43], s75 offen offset:0  lds
    v_accvgpr_write_b32 a11, 0
    v_accvgpr_write_b32 a22, 0
    v_accvgpr_write_b32 a23, 0
    v_and_b32 v7, 15, v1
    v_lshlrev_b32 v7, 7, v7
    v_add_u32_e64 v7, s69, v7
    v_add_u32 v7, 49152, v7
    buffer_load_dwordx4 v14, s[40:43], s75 offen offset:1024  lds
    v_bfe_u32 v8, v1, 1, 3
    v_lshrrev_b32 v9, 4, v1
    v_xor_b32 v8, v8, v9
    v_lshl_add_u32 v11, v8, 4, v7
    v_xor_b32_e64 v8, 4, v8
    v_lshl_add_u32 v12, v8, 4, v7
    s_waitcnt lgkmcnt(0)
    s_mov_b32 exec_lo, 0xf0f0f0f0
    s_mov_b32 exec_hi, 0x0f0f0f0f
    s_nop 0
    v_accvgpr_write_b32 a0, 0
    v_accvgpr_write_b32 a1, 0
    v_accvgpr_write_b32 a2, 0
    v_accvgpr_write_b32 a3, 0
    v_accvgpr_write_b32 a4, 0
    v_accvgpr_write_b32 a5, 0
    v_accvgpr_write_b32 a6, 0
    v_accvgpr_write_b32 a7, 0
    v_accvgpr_write_b32 a8, 0
    v_accvgpr_write_b32 a9, 0
    s_mov_b64 exec, -1
    v_nop
    buffer_load_dwordx4 v15, s[40:43], s75 offen offset:2048  lds
    s_mov_b32 exec_lo, 0xf0f0f0f0
    s_mov_b32 exec_hi, 0x0f0f0f0f
    v_accvgpr_write_b32 a12, 0
    v_accvgpr_write_b32 a13, 0
    v_accvgpr_write_b32 a14, 0
    v_accvgpr_write_b32 a15, 0
    v_accvgpr_write_b32 a16, 0
    v_accvgpr_write_b32 a17, 0
    v_accvgpr_write_b32 a18, 0
    v_accvgpr_write_b32 a19, 0
    v_accvgpr_write_b32 a20, 0
    v_accvgpr_write_b32 a21, 0
    s_mov_b64 exec, -1
    v_nop
    buffer_load_dwordx4 v16, s[40:43], s75 offen offset:3072  lds
    s_add_u32 m0, s69, 16384
    s_add_u32 s75, s64, 512
    buffer_load_dwordx4 v13, s[40:43], s75 offen offset:0  lds
    buffer_load_dwordx4 v14, s[40:43], s75 offen offset:1024  lds
    buffer_load_dwordx4 v15, s[40:43], s75 offen offset:2048  lds
    buffer_load_dwordx4 v16, s[40:43], s75 offen offset:3072  lds
    ds_read_b128 a[24:27], v11 offset:0
    ds_read_b128 a[28:31], v11 offset:2048
    ds_read_b128 a[32:35], v12 offset:0
    ds_read_b128 a[36:39], v12 offset:2048
    s_waitcnt vmcnt(13)
    ds_read_b128 a[40:43], v11 offset:16384
    ds_read_b128 a[44:47], v11 offset:18432
    ds_read_b128 a[48:51], v12 offset:16384
    ds_read_b128 a[52:55], v12 offset:18432
    s_add_u32 m0, s69, 32768
    s_add_u32 s75, s64, 640
    buffer_load_dwordx4 v13, s[40:43], s75 offen offset:0  lds
    buffer_load_dwordx4 v14, s[40:43], s75 offen offset:1024  lds
    buffer_load_dwordx4 v15, s[40:43], s75 offen offset:2048  lds
    buffer_load_dwordx4 v16, s[40:43], s75 offen offset:3072  lds
    s_waitcnt lgkmcnt(0) vmcnt(13)
    ds_read_b128 a[56:59], v11 offset:32768
    ds_read_b128 a[60:63], v11 offset:34816
    ds_read_b128 a[64:67], v12 offset:32768
    ds_read_b128 a[68:71], v12 offset:34816
    s_waitcnt vmcnt(8)
    ds_read_b128 a[72:75], v11 offset:49152
    ds_read_b128 a[76:79], v11 offset:51200
    ds_read_b128 a[80:83], v12 offset:49152
    ds_read_b128 a[84:87], v12 offset:51200
    s_add_u32 m0, s69, 49152
    s_add_u32 s75, s64, 768
    buffer_load_dwordx4 v13, s[40:43], s75 offen offset:0  lds
    buffer_load_dwordx4 v14, s[40:43], s75 offen offset:1024  lds
    buffer_load_dwordx4 v15, s[40:43], s75 offen offset:2048  lds
    buffer_load_dwordx4 v16, s[40:43], s75 offen offset:3072  lds
    s_add_u32 m0, s69, 65536
    s_add_u32 s75, s64, 896
    buffer_load_dwordx4 v13, s[40:43], s75 offen offset:0  lds
    buffer_load_dwordx4 v14, s[40:43], s75 offen offset:1024  lds
    buffer_load_dwordx4 v15, s[40:43], s75 offen offset:2048  lds
    buffer_load_dwordx4 v16, s[40:43], s75 offen offset:3072  lds
    s_cmp_lg_u32 s3, 0
    s_cbranch_scc1 L_pi_19
    s_add_u32 s68, s5, 0
    s_lshl_b32 s68, s68, 8
    s_mov_b64 exec, 1
    v_mov_b32 v6, 0
    buffer_atomic_add v6, v5, s[48:51], s68 offen sc0 sc1
    s_mov_b64 exec, -1
L_pi_19:
    s_waitcnt lgkmcnt(0)
    s_add_u32 m0, s69, 81920
    s_add_u32 s75, s64, 1024
    buffer_load_dwordx4 v13, s[40:43], s75 offen offset:0  lds
    buffer_load_dwordx4 v14, s[40:43], s75 offen offset:1024  lds
    buffer_load_dwordx4 v15, s[40:43], s75 offen offset:2048  lds
    buffer_load_dwordx4 v16, s[40:43], s75 offen offset:3072  lds
    s_mov_b32 s72, 2
    s_mov_b32 s73, 0
    s_mov_b32 s24, 0
    s_mov_b32 s25, 0
    s_mov_b32 s71, 0
    s_mov_b32 s0, 1280
    s_mul_i32 s1, s3, 160
    s_mov_b32 s18, 0
    s_mov_b32 s74, 0x10000
    s_bfm_b64 s[36:37], 40, 0
    s_mov_b32 s44, s30
    s_mov_b32 s45, s31
    s_mov_b32 s46, 2211840
    s_mov_b32 s47, 0x20000
    s_cmp_ge_u32 s2, 252
    s_cbranch_scc1 L_secd_24
    s_cmp_ge_u32 s2, 112
    s_cbranch_scc1 L_w1_23
    s_mov_b32 s72, 0
    s_lshr_b32 s10, s2, 1
    s_and_b32 s11, s2, 1
    s_mul_i32 s12, s10, 37
    s_lshr_b32 s12, s12, 8
    s_mul_i32 s13, s12, 7
    s_sub_u32 s13, s10, s13
    s_mul_i32 s12, s12, 216
    s_lshl_b32 s14, s13, 5
    s_cmp_ge_u32 s13, 3
    s_cselect_b32 s24, 12, 0
    s_add_u32 s14, s14, s24
    s_lshl_b32 s24, s3, 2
    s_add_u32 s14, s14, s24
    s_lshr_b32 s25, s3, 1
    s_mul_i32 s25, s25, 100
    s_add_u32 s24, s24, s25
    s_add_u32 s24, s24, 96
    s_bitcmp1_b32 s3, 0
    s_cselect_b32 s25, 0, 8
    s_cmp_eq_u32 s13, 6
    s_cselect_b32 s14, s24, s14
    s_cselect_b32 s73, 1, 0
    s_cselect_b32 s13, s25, 16
    s_add_u32 s24, s12, s14
    s_add_u32 s25, s24, s13
    s_lshl_b32 s12, s11, 2
    s_add_u32 s12, s12, s3
    s_mul_i32 s12, s12, 56
    s_add_u32 s12, s12, s10
    s_mul_i32 s71, s12, 5120
    s_add_u32 s71, s71, 19759104
    s_mul_i32 s11, s11, 640
    s_branch L_w2_21
L_w1_23:
    s_mov_b32 s44, s26
    s_mov_b32 s45, s27
    s_mov_b32 s46, 2211840
    s_mov_b32 s47, 0x20000
    s_mov_b32 s72, 1
    s_mov_b32 s0, 3456
    s_sub_u32 s11, s2, 112
    s_mul_i32 s10, s11, 147
    s_lshr_b32 s10, s10, 10
    s_mul_i32 s12, s10, 7
    s_sub_u32 s11, s11, s12
    s_mul_i32 s12, s10, 205
    s_lshr_b32 s12, s12, 10
    s_mul_i32 s13, s12, 5
    s_sub_u32 s13, s10, s13
    s_mul_i32 s12, s12, 160
    s_mul_i32 s14, s3, 20
    s_add_u32 s12, s12, s14
    s_lshl_b32 s14, s13, 3
    s_cmp_ge_u32 s13, 2
    s_cselect_b32 s24, 64, 0
    s_add_u32 s14, s14, s24
    s_cmp_ge_u32 s3, 2
    s_cselect_b32 s24, 56, 16
    s_cmp_eq_u32 s13, 4
    s_cselect_b32 s14, s24, s14
    s_cselect_b32 s13, 40, 4
    s_add_u32 s24, s12, s14
    s_add_u32 s25, s24, s13
    s_lshl_b32 s12, s11, 2
    s_add_u32 s12, s12, s3
    s_lshl_b32 s18, s12, 2
    s_mul_i32 s12, s18, 20
    s_add_u32 s12, s12, s10
    s_lshl_b32 s71, s12, 10
    s_add_u32 s71, s71, 17465344
    s_mul_i32 s12, s11, 2352
    s_lshr_b32 s12, s12, 10
    s_lshl_b32 s12, s12, 3
    s_lshl_b32 s11, s11, 9
    s_sub_u32 s11, s11, s12
    s_and_b32 s11, s11, 0xfff0
    s_lshl_b32 s1, s18, 5
    s_sub_u32 s1, s1, s11
    s_sub_u32 s74, 3448, s11
    s_add_u32 s12, s74, 8
    s_lshr_b32 s12, s12, 4
    s_min_u32 s12, s12, 34
    s_bfm_b64 s[36:37], s12, 0
L_w2_21:
    s_mul_i32 s24, s24, s0
    s_mul_i32 s25, s25, s0
    s_add_u32 s24, s24, s11
    s_add_u32 s25, s25, s11
L_secd_24:
    v_lshrrev_b32_e64 v7, 4, v1
    v_lshl_add_u32 v7, v7, 3, v18
    v_mul_u32_u24 v7, 640, v7
    v_and_b32 v8, 3, v1
    s_add_u32 m0, s69, 98304
    s_add_u32 s75, s64, 1152
    buffer_load_dwordx4 v13, s[40:43], s75 offen offset:0  lds
    s_cmp_eq_u32 s72, 1
    s_cselect_b32 s10, 8, 40
    s_cselect_b32 s12, 32, 8
    s_mov_b32 s13, 1024
    s_cmov_b32 s13, 20480
    v_add_u32 v7, 81920, v7
    v_mul_u32_u24 v8, s10, v8
    buffer_load_dwordx4 v14, s[40:43], s75 offen offset:1024  lds
    s_mul_i32 s10, s18, 147
    s_lshr_b32 s10, s10, 10
    s_lshl_b32 s10, s10, 3
    s_sub_u32 s10, s1, s10
    v_add_u32 v9, s10, v8
    v_min_u32 v9, s74, v9
    v_add_u32 v39, v7, v9
    buffer_load_dwordx4 v15, s[40:43], s75 offen offset:2048  lds
    s_add_u32 s18, s18, 1
    s_add_u32 s1, s1, s12
    s_mul_i32 s10, s18, 147
    s_lshr_b32 s10, s10, 10
    s_lshl_b32 s10, s10, 3
    s_sub_u32 s10, s1, s10
    v_add_u32 v9, s10, v8
    v_min_u32 v9, s74, v9
    v_add_u32 v40, v7, v9
    buffer_load_dwordx4 v16, s[40:43], s75 offen offset:3072  lds
    s_add_u32 s18, s18, 1
    s_add_u32 s1, s1, s12
    s_mul_i32 s10, s18, 147
    s_lshr_b32 s10, s10, 10
    s_lshl_b32 s10, s10, 3
    s_sub_u32 s10, s1, s10
    v_add_u32 v9, s10, v8
    v_min_u32 v9, s74, v9
    v_add_u32 v41, v7, v9
    s_add_u32 s18, s18, 1
    s_add_u32 s1, s1, s12
    s_mul_i32 s10, s18, 147
    s_lshr_b32 s10, s10, 10
    s_lshl_b32 s10, s10, 3
    s_sub_u32 s10, s1, s10
    v_add_u32 v9, s10, v8
    v_min_u32 v9, s74, v9
    v_add_u32 v42, v7, v9
    s_add_u32 s18, s18, 1
    s_add_u32 s1, s1, s12
    s_mul_i32 s10, s18, 147
    s_lshr_b32 s10, s10, 10
    s_lshl_b32 s10, s10, 3
    s_sub_u32 s10, s1, s10
    v_add_u32 v9, s10, v8
    v_min_u32 v9, s74, v9
    v_add_u32 v43, v7, v9
    s_cmp_eq_u32 s72, 0
    s_cselect_b32 s1, 0, 1073741824
    s_cmp_eq_u32 s72, 2
    s_cselect_b32 s10, 1073741824, 0
    v_add_u32 v38, s10, v2
    s_mul_i32 s74, s3, 5120
    s_mul_i32 s66, s3, 5120
    s_mul_i32 s15, s3, 12288
    s_sub_u32 s17, s16, 12288
    v_add_u32 v11, 4294934528, v11
    v_add_u32 v12, 4294934528, v12
    s_waitcnt vmcnt(20)
    ds_read_b128 a[88:91], v11 offset:0
    ds_read_b128 a[92:95], v11 offset:2048
    ds_read_b128 a[96:99], v12 offset:0
    ds_read_b128 a[100:103], v12 offset:2048
    s_waitcnt vmcnt(16)
    ds_read_b128 a[104:107], v11 offset:16384
    ds_read_b128 a[108:111], v11 offset:18432
    ds_read_b128 a[112:115], v12 offset:16384
    ds_read_b128 a[116:119], v12 offset:18432
    s_waitcnt lgkmcnt(0)
    s_cmp_lg_u32 s3, 0
    s_cbranch_scc1 L_ok_26
    s_mov_b64 exec, 1
    s_waitcnt vmcnt(8)
    v_cmp_gt_u32 vcc, 16, v6
    s_cbranch_vccz L_pd_29
    s_mov_b32 s70, 0
L_spin_27:
    v_mov_b32 v6, 0
    buffer_atomic_add v6, v5, s[48:51], s68 offen sc0 sc1
    s_add_u32 s70, s70, 1
    s_waitcnt vmcnt(0)
    v_cmp_gt_u32 vcc, 16, v6
    s_cmp_lt_u32 s70, 65536
    s_cselect_b64 vcc, vcc, 0
    s_cbranch_vccnz L_spin_27
L_pd_29:
    s_mov_b64 exec, -1
L_ok_26:
    s_barrier
    s_lshl_b32 s14, s3, 10
    s_add_u32 m0, s14, 0
    s_add_u32 s75, m0, s16
    buffer_load_dwordx4 v2, s[48:51], s75 offen sc1 lds
    s_add_u32 m0, s14, 4096
    s_add_u32 s75, m0, s16
    buffer_load_dwordx4 v2, s[48:51], s75 offen sc1 lds
    s_add_u32 m0, s14, 8192
    s_add_u32 s75, m0, s16
    buffer_load_dwordx4 v2, s[48:51], s75 offen sc1 lds
    s_add_u32 m0, s14, 12288
    s_add_u32 s75, m0, s16
    buffer_load_dwordx4 v2, s[48:51], s75 offen sc1 lds
    s_add_u32 m0, s14, 16384
    s_add_u32 s75, m0, s16
    buffer_load_dwordx4 v2, s[48:51], s75 offen sc1 lds
    v_add_u32 v11, 32768, v11
    v_add_u32 v12, 32768, v12
    s_waitcnt vmcnt(17)
    ds_read_b128 a[120:123], v11 offset:0
    ds_read_b128 a[124:127], v11 offset:2048
    ds_read_b128 a[128:131], v12 offset:0
    ds_read_b128 a[132:135], v12 offset:2048
    s_waitcnt vmcnt(13)
    ds_read_b128 a[136:139], v11 offset:16384
    ds_read_b128 a[140:143], v11 offset:18432
    ds_read_b128 a[144:147], v12 offset:16384
    ds_read_b128 a[148:151], v12 offset:18432
    s_add_u32 m0, s66, 20480
    s_add_u32 s75, m0, s16
    buffer_load_dwordx4 v2, s[48:51], s75 offen offset:0 sc1 lds
    buffer_load_dwordx4 v2, s[48:51], s75 offen offset:1024 sc1 lds
    buffer_load_dwordx4 v2, s[48:51], s75 offen offset:2048 sc1 lds
    buffer_load_dwordx4 v2, s[48:51], s75 offen offset:3072 sc1 lds
    s_add_u32 m0, s66, 24576
    s_add_u32 s75, m0, s16
    buffer_load_dwordx4 v2, s[48:51], s75 offen offset:0 sc1 lds
    s_waitcnt vmcnt(14)
    ds_read_b128 a[152:155], v11 offset:32768
    ds_read_b128 a[156:159], v11 offset:34816
    ds_read_b128 a[160:163], v12 offset:32768
    ds_read_b128 a[164:167], v12 offset:34816
    s_waitcnt vmcnt(10)
    ds_read_b128 a[168:171], v11 offset:49152
    ds_read_b128 a[172:175], v11 offset:51200
    ds_read_b128 a[176:179], v12 offset:49152
    ds_read_b128 a[180:183], v12 offset:51200
    v_mul_u32_u24 v7, 656, v18
    v_and_b32 v8, 3, v1
    v_mul_u32_u24 v8, 40, v8
    s_mul_i32 s10, s3, 160
    s_add_u32 s10, s10, 118784
    v_add3_u32 v7, v7, v8, s10
    v_lshrrev_b32 v8, 4, v1
    v_lshl_add_u32 v9, v8, 3, v7
    ds_read_b64_tr_b16 v[248:249], v9 offset:0
    ds_read_b64_tr_b16 v[250:251], v9 offset:2624
    ds_read_b64_tr_b16 v[252:253], v7 offset:32
    ds_read_b64_tr_b16 v[254:255], v7 offset:2656
    s_cmp_lt_u32 s2, 160
    s_cselect_b32 s10, 0, 1073741824
    s_add_u32 s20, s19, 4096
    v_and_b32 v9, 15, v1
    v_lshlrev_b32_e64 v9, 4, v9
    v_lshl_add_u32 v9, v8, 10, v9
    v_add_u32 v9, s10, v9
    s_waitcnt lgkmcnt(2)
    buffer_store_dwordx4 v[248:251], v9, s[48:51], s19 offen sc1
    s_mov_b64 exec, 0xffff
    s_waitcnt lgkmcnt(0)
    buffer_store_dwordx4 v[252:255], v9, s[48:51], s20 offen sc1
    s_mov_b64 exec, -1
    s_lshl_b32 s67, s5, 2
    s_add_u32 s67, s67, s3
    s_lshl_b32 s67, s67, 11
    s_add_u32 s67, s67, 196608
    s_waitcnt vmcnt(9)
    s_barrier
    ds_read_b128 v[132:135], v2 offset:0
    ds_read_b128 v[136:139], v2 offset:1024
    ds_read_b128 v[140:143], v2 offset:2048
    ds_read_b128 v[144:147], v2 offset:3072
    ds_read_b128 v[148:151], v2 offset:4096
    ds_read_b128 v[152:155], v2 offset:5120
    s_waitcnt lgkmcnt(4)
    v_mfma_f32_16x16x32_bf16 v[176:179], v[132:135], a[24:27], 0
    s_add_u32 m0, s66, 40960
    s_add_u32 s75, m0, s16
    v_mfma_f32_16x16x32_bf16 v[196:199], v[132:135], a[28:31], 0
    ds_read_b128 v[156:159], v2 offset:6144
    v_add_u32 v7, 0, v1
    v_mfma_f32_16x16x32_bf16 v[180:183], v[136:139], a[24:27], 0
    buffer_load_dwordx4 v2, s[48:51], s75 offen offset:0 sc1 lds
    v_mfma_f32_16x16x32_bf16 v[200:203], v[136:139], a[28:31], 0
    ds_read_b128 v[160:163], v2 offset:7168
    s_waitcnt lgkmcnt(4)
    v_mfma_f32_16x16x32_bf16 v[184:187], v[140:143], a[24:27], 0
    v_mul_u32_u24 v7, 205, v7
    v_lshrrev_b32 v7, 11, v7
    v_mfma_f32_16x16x32_bf16 v[204:207], v[140:143], a[28:31], 0
    ds_read_b128 v[132:135], v2 offset:8192
    v_mul_u32_u24 v7, 1120, v7
    v_mfma_f32_16x16x32_bf16 v[188:191], v[144:147], a[24:27], 0
    buffer_load_dwordx4 v2, s[48:51], s75 offen offset:1024 sc1 lds
    v_mfma_f32_16x16x32_bf16 v[208:211], v[144:147], a[28:31], 0
    ds_read_b128 v[136:139], v2 offset:9216
    s_waitcnt lgkmcnt(4)
    v_mfma_f32_16x16x32_bf16 v[192:195], v[148:151], a[24:27], 0
    v_add_u32 v17, v7, v2
    v_add_u32 v7, 64, v1
    v_mfma_f32_16x16x32_bf16 v[212:215], v[148:151], a[28:31], 0
    ds_read_b128 v[140:143], v2 offset:10240
    v_mul_u32_u24 v7, 205, v7
    v_mfma_f32_16x16x32_bf16 v[176:179], v[152:155], a[32:35], v[176:179]
    buffer_load_dwordx4 v2, s[48:51], s75 offen offset:2048 sc1 lds
    v_mfma_f32_16x16x32_bf16 v[196:199], v[152:155], a[36:39], v[196:199]
    ds_read_b128 v[144:147], v2 offset:11264
    s_waitcnt lgkmcnt(4)
    v_mfma_f32_16x16x32_bf16 v[180:183], v[156:159], a[32:35], v[180:183]
    v_lshrrev_b32 v7, 11, v7
    v_mul_u32_u24 v7, 1120, v7
    v_mfma_f32_16x16x32_bf16 v[200:203], v[156:159], a[36:39], v[200:203]
    s_waitcnt vmcnt(10)
    s_barrier
    ds_read_b128 v[148:151], v2 offset:12288
    v_add_u32 v19, v7, v2
    v_mfma_f32_16x16x32_bf16 v[184:187], v[160:163], a[32:35], v[184:187]
    buffer_load_dwordx4 v2, s[48:51], s75 offen offset:3072 sc1 lds
    v_mfma_f32_16x16x32_bf16 v[204:207], v[160:163], a[36:39], v[204:207]
    ds_read_b128 v[152:155], v2 offset:13312
    s_waitcnt lgkmcnt(4)
    v_mfma_f32_16x16x32_bf16 v[188:191], v[132:135], a[32:35], v[188:191]
    s_add_u32 m0, s66, 45056
    s_add_u32 s75, m0, s16
    v_mfma_f32_16x16x32_bf16 v[208:211], v[132:135], a[36:39], v[208:211]
    ds_read_b128 v[156:159], v2 offset:14336
    v_add_u32 v7, 128, v1
    v_mfma_f32_16x16x32_bf16 v[192:195], v[136:139], a[32:35], v[192:195]
    buffer_load_dwordx4 v2, s[48:51], s75 offen offset:0 sc1 lds
    v_mfma_f32_16x16x32_bf16 v[212:215], v[136:139], a[36:39], v[212:215]
    ds_read_b128 v[160:163], v2 offset:15360
    s_waitcnt lgkmcnt(4)
    v_mfma_f32_16x16x32_bf16 v[176:179], v[140:143], a[40:43], v[176:179]
    v_mul_u32_u24 v7, 205, v7
    v_lshrrev_b32 v7, 11, v7
    v_mfma_f32_16x16x32_bf16 v[196:199], v[140:143], a[44:47], v[196:199]
    ds_read_b128 v[132:135], v2 offset:16384
    v_mul_u32_u24 v7, 1120, v7
    v_mfma_f32_16x16x32_bf16 v[180:183], v[144:147], a[40:43], v[180:183]
    buffer_load_dwordx2 v[240:241], v3, s[48:51], s67 offen offset:0 sc1
    v_mfma_f32_16x16x32_bf16 v[200:203], v[144:147], a[44:47], v[200:203]
    ds_read_b128 v[136:139], v2 offset:17408
    s_waitcnt lgkmcnt(4)
    v_mfma_f32_16x16x32_bf16 v[184:187], v[148:151], a[40:43], v[184:187]
    v_add_u32 v21, v7, v2
    v_mfma_f32_16x16x32_bf16 v[204:207], v[148:151], a[44:47], v[204:207]
    ds_read_b128 v[140:143], v2 offset:18432
    v_mfma_f32_16x16x32_bf16 v[188:191], v[152:155], a[40:43], v[188:191]
    buffer_load_dwordx2 v[242:243], v3, s[48:51], s67 offen offset:512 sc1
    v_mfma_f32_16x16x32_bf16 v[208:211], v[152:155], a[44:47], v[208:211]
    ds_read_b128 v[144:147], v2 offset:19456
    s_waitcnt lgkmcnt(4)
    v_mfma_f32_16x16x32_bf16 v[192:195], v[156:159], a[40:43], v[192:195]
    v_mfma_f32_16x16x32_bf16 v[212:215], v[156:159], a[44:47], v[212:215]
    s_waitcnt vmcnt(9)
    s_barrier
    s_cmp_lg_u32 s3, 0
    s_cbranch_scc1 L_sig_30
    s_mov_b64 exec, 1
    s_add_u32 s10, s4, 16
    s_lshl_b32 s10, s10, 8
    buffer_atomic_add v4, v5, s[48:51], s10 offen sc1
    s_mov_b64 exec, -1
L_sig_30:
    ds_read_b128 v[148:151], v2 offset:20480
    v_mfma_f32_16x16x32_bf16 v[176:179], v[160:163], a[48:51], v[176:179]
    buffer_load_dwordx2 v[244:245], v3, s[48:51], s67 offen offset:1024 sc1
    v_mfma_f32_16x16x32_bf16 v[196:199], v[160:163], a[52:55], v[196:199]
    ds_read_b128 v[152:155], v2 offset:21504
    s_waitcnt lgkmcnt(4)
    v_mfma_f32_16x16x32_bf16 v[180:183], v[132:135], a[48:51], v[180:183]
    v_mfma_f32_16x16x32_bf16 v[200:203], v[132:135], a[52:55], v[200:203]
    ds_read_b128 v[156:159], v2 offset:22528
    v_mfma_f32_16x16x32_bf16 v[184:187], v[136:139], a[48:51], v[184:187]
    buffer_load_dwordx2 v[246:247], v3, s[48:51], s67 offen offset:1536 sc1
    v_mfma_f32_16x16x32_bf16 v[204:207], v[136:139], a[52:55], v[204:207]
    ds_read_b128 v[160:163], v2 offset:23552
    s_waitcnt lgkmcnt(4)
    v_mfma_f32_16x16x32_bf16 v[188:191], v[140:143], a[48:51], v[188:191]
    s_add_u32 m0, s66, 61440
    s_add_u32 s75, m0, s16
    v_mfma_f32_16x16x32_bf16 v[208:211], v[140:143], a[52:55], v[208:211]
    ds_read_b128 v[132:135], v2 offset:24576
    v_mfma_f32_16x16x32_bf16 v[192:195], v[144:147], a[48:51], v[192:195]
    buffer_load_dwordx4 v2, s[48:51], s75 offen offset:0 sc1 lds
    v_mfma_f32_16x16x32_bf16 v[212:215], v[144:147], a[52:55], v[212:215]
    ds_read_b128 v[136:139], v2 offset:25600
    s_waitcnt lgkmcnt(4)
    v_mfma_f32_16x16x32_bf16 v[176:179], v[148:151], a[56:59], v[176:179]
    v_mfma_f32_16x16x32_bf16 v[196:199], v[148:151], a[60:63], v[196:199]
    ds_read_b128 v[140:143], v2 offset:26624
    v_mfma_f32_16x16x32_bf16 v[180:183], v[152:155], a[56:59], v[180:183]
    buffer_load_dwordx4 v2, s[48:51], s75 offen offset:1024 sc1 lds
    v_mfma_f32_16x16x32_bf16 v[200:203], v[152:155], a[60:63], v[200:203]
    ds_read_b128 v[144:147], v2 offset:27648
    s_waitcnt lgkmcnt(4)
    v_mfma_f32_16x16x32_bf16 v[184:187], v[156:159], a[56:59], v[184:187]
    v_mfma_f32_16x16x32_bf16 v[204:207], v[156:159], a[60:63], v[204:207]
    ds_read_b128 v[148:151], v2 offset:28672
    v_mfma_f32_16x16x32_bf16 v[188:191], v[160:163], a[56:59], v[188:191]
    buffer_load_dwordx4 v2, s[48:51], s75 offen offset:2048 sc1 lds
    v_mfma_f32_16x16x32_bf16 v[208:211], v[160:163], a[60:63], v[208:211]
    ds_read_b128 v[152:155], v2 offset:29696
    s_waitcnt lgkmcnt(4)
    v_mfma_f32_16x16x32_bf16 v[192:195], v[132:135], a[56:59], v[192:195]
    v_mfma_f32_16x16x32_bf16 v[212:215], v[132:135], a[60:63], v[212:215]
    ds_read_b128 v[156:159], v2 offset:30720
    v_mfma_f32_16x16x32_bf16 v[176:179], v[136:139], a[64:67], v[176:179]
    buffer_load_dwordx4 v2, s[48:51], s75 offen offset:3072 sc1 lds
    v_mfma_f32_16x16x32_bf16 v[196:199], v[136:139], a[68:71], v[196:199]
    ds_read_b128 v[160:163], v2 offset:31744
    s_waitcnt lgkmcnt(4)
    v_mfma_f32_16x16x32_bf16 v[180:183], v[140:143], a[64:67], v[180:183]
    s_add_u32 m0, s66, 65536
    s_add_u32 s75, m0, s16
    v_mfma_f32_16x16x32_bf16 v[200:203], v[140:143], a[68:71], v[200:203]
    ds_read_b128 v[132:135], v2 offset:32768
    v_mfma_f32_16x16x32_bf16 v[184:187], v[144:147], a[64:67], v[184:187]
    buffer_load_dwordx4 v2, s[48:51], s75 offen offset:0 sc1 lds
    v_mfma_f32_16x16x32_bf16 v[204:207], v[144:147], a[68:71], v[204:207]
    ds_read_b128 v[136:139], v2 offset:33792
    s_waitcnt lgkmcnt(4)
    v_mfma_f32_16x16x32_bf16 v[188:191], v[148:151], a[64:67], v[188:191]
    v_mfma_f32_16x16x32_bf16 v[208:211], v[148:151], a[68:71], v[208:211]
    ds_read_b128 v[140:143], v2 offset:34816
    v_mfma_f32_16x16x32_bf16 v[192:195], v[152:155], a[64:67], v[192:195]
    v_mfma_f32_16x16x32_bf16 v[212:215], v[152:155], a[68:71], v[212:215]
    ds_read_b128 v[144:147], v2 offset:35840
    s_waitcnt lgkmcnt(4)
    v_mfma_f32_16x16x32_bf16 v[176:179], v[156:159], a[72:75], v[176:179]
    v_mfma_f32_16x16x32_bf16 v[196:199], v[156:159], a[76:79], v[196:199]
    ds_read_b128 v[148:151], v2 offset:36864
    v_mfma_f32_16x16x32_bf16 v[180:183], v[160:163], a[72:75], v[180:183]
    v_mfma_f32_16x16x32_bf16 v[200:203], v[160:163], a[76:79], v[200:203]
    ds_read_b128 v[152:155], v2 offset:37888
    s_waitcnt lgkmcnt(4)
    v_mfma_f32_16x16x32_bf16 v[184:187], v[132:135], a[72:75], v[184:187]
    v_mfma_f32_16x16x32_bf16 v[204:207], v[132:135], a[76:79], v[204:207]
    ds_read_b128 v[156:159], v2 offset:38912
    v_mfma_f32_16x16x32_bf16 v[188:191], v[136:139], a[72:75], v[188:191]
    v_mfma_f32_16x16x32_bf16 v[208:211], v[136:139], a[76:79], v[208:211]
    ds_read_b128 v[160:163], v2 offset:39936
    s_waitcnt lgkmcnt(4)
    v_mfma_f32_16x16x32_bf16 v[192:195], v[140:143], a[72:75], v[192:195]
    s_cmp_lg_u32 s3, 0
    s_cbranch_scc1 L_pi_32
    s_add_u32 s68, s4, 16
    s_lshl_b32 s68, s68, 8
    s_mov_b64 exec, 1
    v_mov_b32 v6, 0
    buffer_atomic_add v6, v5, s[48:51], s68 offen sc0 sc1
    s_mov_b64 exec, -1
L_pi_32:
    v_mfma_f32_16x16x32_bf16 v[212:215], v[140:143], a[76:79], v[212:215]
    s_waitcnt vmcnt(9)
    s_barrier
    s_cmp_lg_u32 s3, 0
    s_cbranch_scc1 L_sig_34
    s_mov_b64 exec, 1
    s_add_u32 s10, s5, 112
    s_lshl_b32 s10, s10, 8
    buffer_atomic_add v4, v5, s[48:51], s10 offen sc1
    s_mov_b64 exec, -1
L_sig_34:
    ds_read_b128 v[132:135], v2 offset:40960
    s_add_u32 m0, s66, 0
    v_mfma_f32_16x16x32_bf16 v[176:179], v[144:147], a[80:83], v[176:179]
    s_add_u32 s75, m0, s16
    s_add_u32 s75, s75, 81920
    v_mfma_f32_16x16x32_bf16 v[196:199], v[144:147], a[84:87], v[196:199]
    ds_read_b128 v[136:139], v2 offset:41984
    s_waitcnt lgkmcnt(4)
    v_mfma_f32_16x16x32_bf16 v[180:183], v[148:151], a[80:83], v[180:183]
    buffer_load_dwordx4 v2, s[48:51], s75 offen offset:0 sc1 lds
    v_mfma_f32_16x16x32_bf16 v[200:203], v[148:151], a[84:87], v[200:203]
    ds_read_b128 v[140:143], v2 offset:43008
    v_mfma_f32_16x16x32_bf16 v[184:187], v[152:155], a[80:83], v[184:187]
    v_mfma_f32_16x16x32_bf16 v[204:207], v[152:155], a[84:87], v[204:207]
    ds_read_b128 v[144:147], v2 offset:44032
    s_waitcnt lgkmcnt(4)
    v_mfma_f32_16x16x32_bf16 v[188:191], v[156:159], a[80:83], v[188:191]
    buffer_load_dwordx4 v2, s[48:51], s75 offen offset:1024 sc1 lds
    v_mfma_f32_16x16x32_bf16 v[208:211], v[156:159], a[84:87], v[208:211]
    ds_read_b128 v[148:151], v2 offset:45056
    v_mfma_f32_16x16x32_bf16 v[192:195], v[160:163], a[80:83], v[192:195]
    v_mfma_f32_16x16x32_bf16 v[212:215], v[160:163], a[84:87], v[212:215]
    ds_read_b128 v[152:155], v2 offset:46080
    s_waitcnt lgkmcnt(4)
    v_mfma_f32_16x16x32_bf16 v[176:179], v[132:135], a[88:91], v[176:179]
    buffer_load_dwordx4 v2, s[48:51], s75 offen offset:2048 sc1 lds
    v_mfma_f32_16x16x32_bf16 v[196:199], v[132:135], a[92:95], v[196:199]
    ds_read_b128 v[156:159], v2 offset:47104
    v_mfma_f32_16x16x32_bf16 v[180:183], v[136:139], a[88:91], v[180:183]
    s_waitcnt vmcnt(10)
    v_add_f32 v240, v240, v242
    v_add_f32 v241, v241, v243
    v_mfma_f32_16x16x32_bf16 v[200:203], v[136:139], a[92:95], v[200:203]
    ds_read_b128 v[160:163], v2 offset:48128
    s_waitcnt lgkmcnt(4)
    v_mfma_f32_16x16x32_bf16 v[184:187], v[140:143], a[88:91], v[184:187]
    buffer_load_dwordx4 v2, s[48:51], s75 offen offset:3072 sc1 lds
    v_mfma_f32_16x16x32_bf16 v[204:207], v[140:143], a[92:95], v[204:207]
    ds_read_b128 v[132:135], v2 offset:49152
    s_add_u32 m0, s66, 4096
    v_mfma_f32_16x16x32_bf16 v[188:191], v[144:147], a[88:91], v[188:191]
    s_add_u32 s75, m0, s16
    s_add_u32 s75, s75, 81920
    v_mfma_f32_16x16x32_bf16 v[208:211], v[144:147], a[92:95], v[208:211]
    ds_read_b128 v[136:139], v2 offset:50176
    s_waitcnt lgkmcnt(4)
    v_mfma_f32_16x16x32_bf16 v[192:195], v[148:151], a[88:91], v[192:195]
    buffer_load_dwordx4 v2, s[48:51], s75 offen offset:0 sc1 lds
    v_mfma_f32_16x16x32_bf16 v[212:215], v[148:151], a[92:95], v[212:215]
    ds_read_b128 v[140:143], v2 offset:51200
    s_waitcnt vmcnt(10)
    v_add_f32 v244, v244, v246
    v_mfma_f32_16x16x32_bf16 v[176:179], v[152:155], a[96:99], v[176:179]
    v_add_f32 v245, v245, v247
    v_add_f32 v240, v240, v244
    v_mfma_f32_16x16x32_bf16 v[196:199], v[152:155], a[100:103], v[196:199]
    ds_read_b128 v[144:147], v2 offset:52224
    s_waitcnt lgkmcnt(4)
    v_mfma_f32_16x16x32_bf16 v[180:183], v[156:159], a[96:99], v[180:183]
    v_add_f32 v241, v241, v245
    ds_write_b64 v29, v[240:241]
    v_mfma_f32_16x16x32_bf16 v[200:203], v[156:159], a[100:103], v[200:203]
    ds_read_b128 v[148:151], v2 offset:53248
    v_mfma_f32_16x16x32_bf16 v[184:187], v[160:163], a[96:99], v[184:187]
    v_mfma_f32_16x16x32_bf16 v[204:207], v[160:163], a[100:103], v[204:207]
    ds_read_b128 v[152:155], v2 offset:54272
    s_waitcnt lgkmcnt(5)
    v_mfma_f32_16x16x32_bf16 v[188:191], v[132:135], a[96:99], v[188:191]
    v_mfma_f32_16x16x32_bf16 v[208:211], v[132:135], a[100:103], v[208:211]
    ds_read_b128 v[156:159], v2 offset:55296
    v_mfma_f32_16x16x32_bf16 v[192:195], v[136:139], a[96:99], v[192:195]
    v_mfma_f32_16x16x32_bf16 v[212:215], v[136:139], a[100:103], v[212:215]
    ds_read_b128 v[160:163], v2 offset:56320
    s_waitcnt lgkmcnt(5)
    v_mfma_f32_16x16x32_bf16 v[176:179], v[140:143], a[104:107], v[176:179]
    v_mfma_f32_16x16x32_bf16 v[196:199], v[140:143], a[108:111], v[196:199]
    ds_read_b128 v[132:135], v2 offset:57344
    v_mfma_f32_16x16x32_bf16 v[180:183], v[144:147], a[104:107], v[180:183]
    v_mfma_f32_16x16x32_bf16 v[200:203], v[144:147], a[108:111], v[200:203]
    ds_read_b128 v[136:139], v2 offset:58368
    s_waitcnt lgkmcnt(4)
    v_mfma_f32_16x16x32_bf16 v[184:187], v[148:151], a[104:107], v[184:187]
    v_mfma_f32_16x16x32_bf16 v[204:207], v[148:151], a[108:111], v[204:207]
    ds_read_b128 v[140:143], v2 offset:59392
    v_mfma_f32_16x16x32_bf16 v[188:191], v[152:155], a[104:107], v[188:191]
    v_mfma_f32_16x16x32_bf16 v[208:211], v[152:155], a[108:111], v[208:211]
    ds_read_b128 v[144:147], v2 offset:60416
    s_waitcnt lgkmcnt(4)
    v_mfma_f32_16x16x32_bf16 v[192:195], v[156:159], a[104:107], v[192:195]
    v_mfma_f32_16x16x32_bf16 v[212:215], v[156:159], a[108:111], v[212:215]
    s_waitcnt vmcnt(5)
    s_cmp_lg_u32 s3, 0
    s_cbranch_scc1 L_ok_36
    s_mov_b64 exec, 1
    v_cmp_gt_u32 vcc, 16, v6
    s_cbranch_vccz L_pd_39
    s_mov_b32 s70, 0
L_spin_37:
    v_mov_b32 v6, 0
    buffer_atomic_add v6, v5, s[48:51], s68 offen sc0 sc1
    s_add_u32 s70, s70, 1
    s_waitcnt vmcnt(0)
    v_cmp_gt_u32 vcc, 16, v6
    s_cmp_lt_u32 s70, 65536
    s_cselect_b64 vcc, vcc, 0
    s_cbranch_vccnz L_spin_37
L_pd_39:
    s_mov_b64 exec, -1
L_ok_36:
    s_barrier
    ds_read_b128 v[148:151], v27 offset:0
    v_mfma_f32_16x16x32_bf16 v[176:179], v[160:163], a[112:115], v[176:179]
    buffer_load_dwordx2 v[22:23], v28, s[48:51], 0 offen offset:0 sc1
    v_mfma_f32_16x16x32_bf16 v[196:199], v[160:163], a[116:119], v[196:199]
    ds_read_b128 v[152:155], v27 offset:1024
    s_waitcnt lgkmcnt(4)
    v_mfma_f32_16x16x32_bf16 v[180:183], v[132:135], a[112:115], v[180:183]
    ds_read_b64 v[240:241], v31 offset:0
    ds_read_b64 v[242:243], v31 offset:512
    v_mfma_f32_16x16x32_bf16 v[200:203], v[132:135], a[116:119], v[200:203]
    ds_read_b128 v[156:159], v27 offset:2048
    ds_read_b64 v[244:245], v31 offset:1024
    v_mfma_f32_16x16x32_bf16 v[184:187], v[136:139], a[112:115], v[184:187]
    buffer_load_dwordx2 v[24:25], v28, s[48:51], 0 offen offset:1024 sc1
    v_mfma_f32_16x16x32_bf16 v[204:207], v[136:139], a[116:119], v[204:207]
    ds_read_b128 v[160:163], v27 offset:3072
    s_waitcnt lgkmcnt(7)
    v_mfma_f32_16x16x32_bf16 v[188:191], v[140:143], a[112:115], v[188:191]
    ds_read_b64 v[246:247], v31 offset:1536
    v_mfma_f32_16x16x32_bf16 v[208:211], v[140:143], a[116:119], v[208:211]
    ds_read_b128 v[132:135], v27 offset:4096
    v_mfma_f32_16x16x32_bf16 v[192:195], v[144:147], a[112:115], v[192:195]
    s_cmp_lg_u32 s3, 3
    s_cbranch_scc1 L_nob_40
    v_min_u32 v10, 26, v1
    v_lshlrev_b32 v10, 7, v10
    global_load_dword v6, v10, s[28:29]
    v_min_u32 v10, 1152, v10
    global_load_dword v6, v10, s[32:33]
L_nob_40:
    v_mfma_f32_16x16x32_bf16 v[212:215], v[144:147], a[116:119], v[212:215]
    ds_read_b128 v[136:139], v27 offset:5120
    s_waitcnt lgkmcnt(8)
    v_mfma_f32_16x16x32_bf16 v[176:179], v[148:151], a[120:123], v[176:179]
    s_add_u32 m0, s74, 81920
    v_mfma_f32_16x16x32_bf16 v[196:199], v[148:151], a[124:127], v[196:199]
    ds_read_b128 v[140:143], v27 offset:6144
    v_mfma_f32_16x16x32_bf16 v[180:183], v[152:155], a[120:123], v[180:183]
    s_mov_b64 exec, s[36:37]
    buffer_load_dwordx4 v38, s[44:47], s24 offen nt lds
    s_mov_b64 exec, -1
    v_mfma_f32_16x16x32_bf16 v[200:203], v[152:155], a[124:127], v[200:203]
    ds_read_b128 v[144:147], v27 offset:7168
    s_waitcnt lgkmcnt(5)
    v_mfma_f32_16x16x32_bf16 v[184:187], v[156:159], a[120:123], v[184:187]
    s_add_u32 s24, s24, s0
    s_add_u32 m0, s74, 82560
    v_mfma_f32_16x16x32_bf16 v[204:207], v[156:159], a[124:127], v[204:207]
    ds_read_b128 v[148:151], v27 offset:8192
    v_add_f32 v240, v240, v242
    v_mfma_f32_16x16x32_bf16 v[188:191], v[160:163], a[120:123], v[188:191]
    s_mov_b64 exec, s[36:37]
    buffer_load_dwordx4 v38, s[44:47], s24 offen nt lds
    s_mov_b64 exec, -1
    v_mfma_f32_16x16x32_bf16 v[208:211], v[160:163], a[124:127], v[208:211]
    ds_read_b128 v[152:155], v27 offset:9216
    s_waitcnt lgkmcnt(4)
    v_mfma_f32_16x16x32_bf16 v[192:195], v[132:135], a[120:123], v[192:195]
    s_add_u32 s24, s24, s0
    s_add_u32 m0, s74, 83200
    v_mfma_f32_16x16x32_bf16 v[212:215], v[132:135], a[124:127], v[212:215]
    ds_read_b128 v[156:159], v27 offset:10240
    v_add_f32 v241, v241, v243
    v_mfma_f32_16x16x32_bf16 v[176:179], v[136:139], a[128:131], v[176:179]
    s_mov_b64 exec, s[36:37]
    buffer_load_dwordx4 v38, s[44:47], s24 offen nt lds
    s_mov_b64 exec, -1
    v_mfma_f32_16x16x32_bf16 v[196:199], v[136:139], a[132:135], v[196:199]
    ds_read_b128 v[160:163], v27 offset:11264
    s_waitcnt lgkmcnt(4)
    v_mfma_f32_16x16x32_bf16 v[180:183], v[140:143], a[128:131], v[180:183]
    s_add_u32 s24, s24, s0
    s_add_u32 m0, s74, 83840
    v_mfma_f32_16x16x32_bf16 v[200:203], v[140:143], a[132:135], v[200:203]
    ds_read_b128 v[132:135], v27 offset:12288
    v_add_f32 v244, v244, v246
    v_mfma_f32_16x16x32_bf16 v[184:187], v[144:147], a[128:131], v[184:187]
    s_mov_b64 exec, s[36:37]
    buffer_load_dwordx4 v38, s[44:47], s24 offen nt lds
    s_mov_b64 exec, -1
    v_mfma_f32_16x16x32_bf16 v[204:207], v[144:147], a[132:135], v[204:207]
    ds_read_b128 v[136:139], v27 offset:13312
    s_waitcnt lgkmcnt(4)
    v_mfma_f32_16x16x32_bf16 v[188:191], v[148:151], a[128:131], v[188:191]
    s_add_u32 m0, s74, 84480
    v_add_f32 v245, v245, v247
    v_mfma_f32_16x16x32_bf16 v[208:211], v[148:151], a[132:135], v[208:211]
    ds_read_b128 v[140:143], v27 offset:14336
    v_add_f32 v240, v240, v244
    v_mfma_f32_16x16x32_bf16 v[192:195], v[152:155], a[128:131], v[192:195]
    s_mov_b64 exec, s[36:37]
    buffer_load_dwordx4 v38, s[44:47], s25 offen nt lds
    s_mov_b64 exec, -1
    v_mfma_f32_16x16x32_bf16 v[212:215], v[152:155], a[132:135], v[212:215]
    ds_read_b128 v[144:147], v27 offset:15360
    s_waitcnt lgkmcnt(4)
    v_mfma_f32_16x16x32_bf16 v[176:179], v[156:159], a[136:139], v[176:179]
    s_add_u32 s25, s25, s0
    s_add_u32 m0, s74, 85120
    v_mfma_f32_16x16x32_bf16 v[196:199], v[156:159], a[140:143], v[196:199]
    ds_read_b128 v[148:151], v27 offset:16384
    v_add_f32 v241, v241, v245
    v_mfma_f32_16x16x32_bf16 v[180:183], v[160:163], a[136:139], v[180:183]
    s_mov_b64 exec, s[36:37]
    buffer_load_dwordx4 v38, s[44:47], s25 offen nt lds
    s_mov_b64 exec, -1
    v_mfma_f32_16x16x32_bf16 v[200:203], v[160:163], a[140:143], v[200:203]
    ds_read_b128 v[152:155], v27 offset:17408
    s_waitcnt lgkmcnt(4)
    v_mfma_f32_16x16x32_bf16 v[184:187], v[132:135], a[136:139], v[184:187]
    s_add_u32 s25, s25, s0
    s_add_u32 m0, s74, 85760
    v_mfma_f32_16x16x32_bf16 v[204:207], v[132:135], a[140:143], v[204:207]
    ds_read_b128 v[156:159], v27 offset:18432
    ds_write_b64 v29, v[240:241] offset:2048
    v_mfma_f32_16x16x32_bf16 v[188:191], v[136:139], a[136:139], v[188:191]
    ds_read_b128 v[88:91], v30 offset:2048
    ds_read_b128 v[92:95], v30 offset:2112
    v_mfma_f32_16x16x32_bf16 v[208:211], v[136:139], a[140:143], v[208:211]
    ds_read_b128 v[160:163], v27 offset:19456
    s_waitcnt lgkmcnt(7)
    v_mfma_f32_16x16x32_bf16 v[192:195], v[140:143], a[136:139], v[192:195]
    s_mov_b64 exec, s[36:37]
    buffer_load_dwordx4 v38, s[44:47], s25 offen nt lds
    s_mov_b64 exec, -1
    v_mfma_f32_16x16x32_bf16 v[212:215], v[140:143], a[140:143], v[212:215]
    s_waitcnt vmcnt(9)
    s_barrier
    ds_read_b128 v[132:135], v2 offset:0
    s_add_u32 s25, s25, s0
    v_mfma_f32_16x16x32_bf16 v[176:179], v[144:147], a[144:147], v[176:179]
    s_add_u32 m0, s74, 86400
    ds_read_b128 v[96:99], v30 offset:2176
    v_mfma_f32_16x16x32_bf16 v[196:199], v[144:147], a[148:151], v[196:199]
    ds_read_b128 v[136:139], v2 offset:1024
    s_waitcnt lgkmcnt(8)
    v_mfma_f32_16x16x32_bf16 v[180:183], v[148:151], a[144:147], v[180:183]
    ds_read_b128 v[100:103], v30 offset:2240
    ds_read_b128 v[104:107], v30 offset:2304
    v_mfma_f32_16x16x32_bf16 v[200:203], v[148:151], a[148:151], v[200:203]
    ds_read_b128 v[140:143], v2 offset:2048
    ds_read_b128 v[120:123], v30 offset:2368
    v_mfma_f32_16x16x32_bf16 v[184:187], v[152:155], a[144:147], v[184:187]
    s_mov_b64 exec, s[36:37]
    buffer_load_dwordx4 v38, s[44:47], s25 offen nt lds
    s_mov_b64 exec, -1
    v_mfma_f32_16x16x32_bf16 v[204:207], v[152:155], a[148:151], v[204:207]
    ds_read_b128 v[144:147], v2 offset:3072
    s_waitcnt lgkmcnt(8)
    v_mfma_f32_16x16x32_bf16 v[188:191], v[156:159], a[144:147], v[188:191]
    ds_read_b128 v[124:127], v30 offset:2432
    ds_read_b128 v[128:131], v30 offset:2496
    v_mfma_f32_16x16x32_bf16 v[208:211], v[156:159], a[148:151], v[208:211]
    ds_read_b128 v[148:151], v2 offset:4096
    v_mfma_f32_16x16x32_bf16 v[192:195], v[160:163], a[144:147], v[192:195]
    s_waitcnt vmcnt(9)
    v_mul_f32 v68, v23, v88
    s_waitcnt vmcnt(8)
    v_mul_f32 v88, v25, v88
    v_mfma_f32_16x16x32_bf16 v[212:215], v[160:163], a[148:151], v[212:215]
    ds_read_b128 v[152:155], v2 offset:5120
    s_waitcnt lgkmcnt(9)
    v_mfma_f32_16x16x32_bf16 v[176:179], v[132:135], a[152:155], v[176:179]
    v_mul_f32 v69, v23, v89
    v_mul_f32 v89, v25, v89
    v_mfma_f32_16x16x32_bf16 v[196:199], v[132:135], a[156:159], v[196:199]
    ds_read_b128 v[156:159], v2 offset:6144
    v_mul_f32 v70, v23, v90
    v_mfma_f32_16x16x32_bf16 v[180:183], v[136:139], a[152:155], v[180:183]
    v_mul_f32 v90, v25, v90
    v_mul_f32 v71, v23, v91
    v_mfma_f32_16x16x32_bf16 v[200:203], v[136:139], a[156:159], v[200:203]
    ds_read_b128 v[160:163], v2 offset:7168
    s_waitcnt lgkmcnt(6)
    v_mfma_f32_16x16x32_bf16 v[184:187], v[140:143], a[152:155], v[184:187]
    s_add_u32 m0, s15, 114688
    s_add_u32 s75, m0, s17
    v_mfma_f32_16x16x32_bf16 v[204:207], v[140:143], a[156:159], v[204:207]
    ds_read_b128 v[132:135], v2 offset:8192
    v_mul_f32 v91, v25, v91
    v_mfma_f32_16x16x32_bf16 v[188:191], v[144:147], a[152:155], v[188:191]
    v_mul_f32 v72, v23, v92
    v_mul_f32 v92, v25, v92
    v_mfma_f32_16x16x32_bf16 v[208:211], v[144:147], a[156:159], v[208:211]
    ds_read_b128 v[136:139], v2 offset:9216
    s_waitcnt lgkmcnt(4)
    v_mfma_f32_16x16x32_bf16 v[192:195], v[148:151], a[152:155], v[192:195]
    buffer_load_dwordx4 v2, s[48:51], s75 offen offset:0 sc1 lds
    v_mfma_f32_16x16x32_bf16 v[212:215], v[148:151], a[156:159], v[212:215]
    ds_read_b128 v[140:143], v2 offset:10240
    v_mul_f32 v73, v23, v93
    v_mfma_f32_16x16x32_bf16 v[176:179], v[152:155], a[160:163], v[176:179]
    v_mul_f32 v93, v25, v93
    v_mul_f32 v74, v23, v94
    v_mfma_f32_16x16x32_bf16 v[196:199], v[152:155], a[164:167], v[196:199]
    ds_read_b128 v[144:147], v2 offset:11264
    s_waitcnt lgkmcnt(4)
    v_mfma_f32_16x16x32_bf16 v[180:183], v[156:159], a[160:163], v[180:183]
    buffer_load_dwordx4 v2, s[48:51], s75 offen offset:1024 sc1 lds
    v_mfma_f32_16x16x32_bf16 v[200:203], v[156:159], a[164:167], v[200:203]
    ds_read_b128 v[148:151], v2 offset:12288
    v_mul_f32 v94, v25, v94
    v_mfma_f32_16x16x32_bf16 v[184:187], v[160:163], a[160:163], v[184:187]
    v_mul_f32 v75, v23, v95
    v_mul_f32 v95, v25, v95
    v_mfma_f32_16x16x32_bf16 v[204:207], v[160:163], a[164:167], v[204:207]
    ds_read_b128 v[152:155], v2 offset:13312
    s_waitcnt lgkmcnt(4)
    v_mfma_f32_16x16x32_bf16 v[188:191], v[132:135], a[160:163], v[188:191]
    buffer_load_dwordx4 v2, s[48:51], s75 offen offset:2048 sc1 lds
    v_mfma_f32_16x16x32_bf16 v[208:211], v[132:135], a[164:167], v[208:211]
    ds_read_b128 v[156:159], v2 offset:14336
    v_mul_f32 v76, v23, v96
    v_mfma_f32_16x16x32_bf16 v[192:195], v[136:139], a[160:163], v[192:195]
    v_mul_f32 v96, v25, v96
    v_mul_f32 v77, v23, v97
    v_mfma_f32_16x16x32_bf16 v[212:215], v[136:139], a[164:167], v[212:215]
    ds_read_b128 v[160:163], v2 offset:15360
    s_waitcnt lgkmcnt(4)
    v_mfma_f32_16x16x32_bf16 v[176:179], v[140:143], a[168:171], v[176:179]
    buffer_load_dwordx4 v2, s[48:51], s75 offen offset:3072 sc1 lds
    v_mfma_f32_16x16x32_bf16 v[196:199], v[140:143], a[172:175], v[196:199]
    ds_read_b128 v[132:135], v2 offset:16384
    v_mul_f32 v97, v25, v97
    v_mfma_f32_16x16x32_bf16 v[180:183], v[144:147], a[168:171], v[180:183]
    v_mul_f32 v78, v23, v98
    v_mul_f32 v98, v25, v98
    v_mfma_f32_16x16x32_bf16 v[200:203], v[144:147], a[172:175], v[200:203]
    ds_read_b128 v[136:139], v2 offset:17408
    s_waitcnt lgkmcnt(4)
    v_mfma_f32_16x16x32_bf16 v[184:187], v[148:151], a[168:171], v[184:187]
    v_mul_f32 v79, v23, v99
    v_mul_f32 v99, v25, v99
    v_mfma_f32_16x16x32_bf16 v[204:207], v[148:151], a[172:175], v[204:207]
    ds_read_b128 v[140:143], v2 offset:18432
    v_mul_f32 v80, v23, v100
    v_mfma_f32_16x16x32_bf16 v[188:191], v[152:155], a[168:171], v[188:191]
    v_mul_f32 v100, v25, v100
    v_mul_f32 v81, v23, v101
    v_mfma_f32_16x16x32_bf16 v[208:211], v[152:155], a[172:175], v[208:211]
    ds_read_b128 v[144:147], v2 offset:19456
    s_waitcnt lgkmcnt(4)
    v_mfma_f32_16x16x32_bf16 v[192:195], v[156:159], a[168:171], v[192:195]
    v_mul_f32 v101, v25, v101
    v_mul_f32 v82, v23, v102
    v_mfma_f32_16x16x32_bf16 v[212:215], v[156:159], a[172:175], v[212:215]
    v_mul_f32 v102, v25, v102
    v_mul_f32 v83, v23, v103
    v_mfma_f32_16x16x32_bf16 v[176:179], v[160:163], a[176:179], v[176:179]
    v_mul_f32 v103, v25, v103
    v_mul_f32 v84, v23, v104
    v_mfma_f32_16x16x32_bf16 v[196:199], v[160:163], a[180:183], v[196:199]
    v_mul_f32 v104, v25, v104
    s_waitcnt lgkmcnt(2)
    v_mfma_f32_16x16x32_bf16 v[180:183], v[132:135], a[176:179], v[180:183]
    v_mul_f32 v85, v23, v105
    v_mul_f32 v105, v25, v105
    v_mfma_f32_16x16x32_bf16 v[200:203], v[132:135], a[180:183], v[200:203]
    v_mul_f32 v86, v23, v106
    v_mul_f32 v106, v25, v106
    v_mfma_f32_16x16x32_bf16 v[184:187], v[136:139], a[176:179], v[184:187]
    v_mul_f32 v87, v23, v107
    v_mul_f32 v107, v25, v107
    v_mfma_f32_16x16x32_bf16 v[204:207], v[136:139], a[180:183], v[204:207]
    s_waitcnt lgkmcnt(0)
    v_mfma_f32_16x16x32_bf16 v[188:191], v[140:143], a[176:179], v[188:191]
    v_mfma_f32_16x16x32_bf16 v[208:211], v[140:143], a[180:183], v[208:211]
    v_mfma_f32_16x16x32_bf16 v[192:195], v[144:147], a[176:179], v[192:195]
    v_mfma_f32_16x16x32_bf16 v[212:215], v[144:147], a[180:183], v[212:215]
    v_mov_b32 v174, 0
    v_mov_b32 v175, 0
    v_pk_fma_f32 v[176:177], v[176:177], v[22:23], v[68:69] op_sel_hi:[1,0,1]
    v_pk_fma_f32 v[178:179], v[178:179], v[22:23], v[70:71] op_sel_hi:[1,0,1]
    v_pk_fma_f32 v[180:181], v[180:181], v[22:23], v[72:73] op_sel_hi:[1,0,1]
    v_pk_fma_f32 v[182:183], v[182:183], v[22:23], v[74:75] op_sel_hi:[1,0,1]
    v_pk_fma_f32 v[184:185], v[184:185], v[22:23], v[76:77] op_sel_hi:[1,0,1]
    v_pk_fma_f32 v[186:187], v[186:187], v[22:23], v[78:79] op_sel_hi:[1,0,1]
    v_pk_fma_f32 v[188:189], v[188:189], v[22:23], v[80:81] op_sel_hi:[1,0,1]
    v_pk_fma_f32 v[190:191], v[190:191], v[22:23], v[82:83] op_sel_hi:[1,0,1]
    v_pk_fma_f32 v[192:193], v[192:193], v[22:23], v[84:85] op_sel_hi:[1,0,1]
    v_pk_fma_f32 v[194:195], v[194:195], v[22:23], v[86:87] op_sel_hi:[1,0,1]
    v_pk_fma_f32 v[196:197], v[196:197], v[24:25], v[88:89] op_sel_hi:[1,0,1]
    v_pk_fma_f32 v[198:199], v[198:199], v[24:25], v[90:91] op_sel_hi:[1,0,1]
    v_pk_fma_f32 v[200:201], v[200:201], v[24:25], v[92:93] op_sel_hi:[1,0,1]
    v_pk_fma_f32 v[202:203], v[202:203], v[24:25], v[94:95] op_sel_hi:[1,0,1]
    v_pk_fma_f32 v[204:205], v[204:205], v[24:25], v[96:97] op_sel_hi:[1,0,1]
    v_pk_fma_f32 v[206:207], v[206:207], v[24:25], v[98:99] op_sel_hi:[1,0,1]
    v_pk_fma_f32 v[208:209], v[208:209], v[24:25], v[100:101] op_sel_hi:[1,0,1]
    v_pk_fma_f32 v[210:211], v[210:211], v[24:25], v[102:103] op_sel_hi:[1,0,1]
    v_pk_fma_f32 v[212:213], v[212:213], v[24:25], v[104:105] op_sel_hi:[1,0,1]
    v_pk_fma_f32 v[214:215], v[214:215], v[24:25], v[106:107] op_sel_hi:[1,0,1]
    v_cvt_pk_bf16_f32 v164, v176, v177
    v_cvt_pk_bf16_f32 v132, v196, v197
    v_cvt_pk_bf16_f32 v165, v178, v179
    v_cvt_pk_bf16_f32 v133, v198, v199
    v_cvt_pk_bf16_f32 v166, v180, v181
    v_cvt_pk_bf16_f32 v134, v200, v201
    v_cvt_pk_bf16_f32 v167, v182, v183
    v_cvt_pk_bf16_f32 v135, v202, v203
    v_permlane16_swap_b32 v164, v132
    v_permlane16_swap_b32 v165, v133
    v_permlane16_swap_b32 v166, v134
    v_permlane16_swap_b32 v167, v135
    s_nop 1
    v_mfma_f32_32x32x16_bf16 v[52:67], a[0:3], v[164:167], 0
    v_cvt_pk_bf16_f32 v168, v184, v185
    v_cvt_pk_bf16_f32 v136, v204, v205
    v_cvt_pk_bf16_f32 v169, v186, v187
    v_cvt_pk_bf16_f32 v137, v206, v207
    v_cvt_pk_bf16_f32 v170, v188, v189
    v_cvt_pk_bf16_f32 v138, v208, v209
    v_mfma_f32_32x32x16_bf16 v[240:255], a[12:15], v[164:167], 0
    v_cvt_pk_bf16_f32 v171, v190, v191
    v_cvt_pk_bf16_f32 v139, v210, v211
    v_permlane16_swap_b32 v168, v136
    v_permlane16_swap_b32 v169, v137
    v_permlane16_swap_b32 v170, v138
    v_permlane16_swap_b32 v171, v139
    s_nop 1
    v_mfma_f32_32x32x16_bf16 v[52:67], a[4:7], v[168:171], v[52:67]
    s_lshl_b32 s64, s5, 4
    s_mul_i32 s65, s64, 3840
    s_add_u32 s65, s65, 2949120
    s_mul_i32 s64, s4, 3840
    s_add_u32 s64, s64, s65
    v_mfma_f32_32x32x16_bf16 v[240:255], a[16:19], v[168:171], v[240:255]
    v_cvt_pk_bf16_f32 v172, v192, v193
    v_cvt_pk_bf16_f32 v140, v212, v213
    v_cvt_pk_bf16_f32 v173, v194, v195
    v_cvt_pk_bf16_f32 v141, v214, v215
    v_permlane16_swap_b32 v172, v140
    s_nop 0
    v_permlane16_swap_b32 v173, v141
    s_nop 1
    v_mfma_f32_32x32x16_bf16 v[52:67], a[8:11], v[172:175], v[52:67]
    s_mul_i32 s0, s3, 25600
    s_mul_i32 s24, s7, 102400
    s_add_u32 s24, s24, s0
    s_add_u32 s24, s24, 16646144
    v_mfma_f32_32x32x16_bf16 v[240:255], a[20:23], v[172:175], v[240:255]
    v_mov_b32 v142, s61
    v_mov_b32 v143, 0
    s_barrier
    s_nop 3
    v_max3_f32 v12, v52, v53, v54
    v_max3_f32 v13, v55, v56, v57
    s_add_u32 m0, s15, 118784
    s_add_u32 s75, m0, s17
    buffer_load_dwordx4 v2, s[48:51], s75 offen offset:0 sc1 lds
    v_max3_f32 v12, v12, v58, v59
    v_max3_f32 v13, v13, v60, v61
    v_max3_f32 v12, v12, v62, v63
    v_max3_f32 v13, v13, v64, v65
    v_max3_f32 v12, v12, v66, v67
    v_max3_f32 v13, v13, v240, v241
    v_max3_f32 v12, v12, v242, v243
    v_max3_f32 v12, v12, v13, v13
    v_mul_f32 v13, s63, v12
    v_mov_b32 v12, s63
    buffer_load_dwordx4 v2, s[48:51], s75 offen offset:1024 sc1 lds
    v_pk_fma_f32 v[68:69], v[52:53], v[12:13], v[12:13] op_sel:[0,0,1] op_sel_hi:[1,0,1] neg_lo:[0,0,1] neg_hi:[0,0,1]
    v_pk_fma_f32 v[70:71], v[54:55], v[12:13], v[12:13] op_sel:[0,0,1] op_sel_hi:[1,0,1] neg_lo:[0,0,1] neg_hi:[0,0,1]
    v_pk_fma_f32 v[72:73], v[56:57], v[12:13], v[12:13] op_sel:[0,0,1] op_sel_hi:[1,0,1] neg_lo:[0,0,1] neg_hi:[0,0,1]
    v_pk_fma_f32 v[74:75], v[58:59], v[12:13], v[12:13] op_sel:[0,0,1] op_sel_hi:[1,0,1] neg_lo:[0,0,1] neg_hi:[0,0,1]
    v_pk_fma_f32 v[76:77], v[60:61], v[12:13], v[12:13] op_sel:[0,0,1] op_sel_hi:[1,0,1] neg_lo:[0,0,1] neg_hi:[0,0,1]
    v_pk_fma_f32 v[78:79], v[62:63], v[12:13], v[12:13] op_sel:[0,0,1] op_sel_hi:[1,0,1] neg_lo:[0,0,1] neg_hi:[0,0,1]
    v_pk_fma_f32 v[80:81], v[64:65], v[12:13], v[12:13] op_sel:[0,0,1] op_sel_hi:[1,0,1] neg_lo:[0,0,1] neg_hi:[0,0,1]
    v_pk_fma_f32 v[82:83], v[66:67], v[12:13], v[12:13] op_sel:[0,0,1] op_sel_hi:[1,0,1] neg_lo:[0,0,1] neg_hi:[0,0,1]
    v_pk_fma_f32 v[84:85], v[240:241], v[12:13], v[12:13] op_sel:[0,0,1] op_sel_hi:[1,0,1] neg_lo:[0,0,1] neg_hi:[0,0,1]
    buffer_load_dwordx4 v2, s[48:51], s75 offen offset:2048 sc1 lds
    v_pk_fma_f32 v[86:87], v[242:243], v[12:13], v[12:13] op_sel:[0,0,1] op_sel_hi:[1,0,1] neg_lo:[0,0,1] neg_hi:[0,0,1]
    v_exp_f32 v68, v68
    v_exp_f32 v69, v69
    v_exp_f32 v70, v70
    v_exp_f32 v71, v71
    ds_write_b128 v32, v[132:135] offset:0
    buffer_load_dwordx4 v2, s[48:51], s75 offen offset:3072 sc1 lds
    v_exp_f32 v72, v72
    v_exp_f32 v73, v73
    v_pk_add_f32 v[14:15], v[68:69], v[70:71]
    v_exp_f32 v74, v74
    v_exp_f32 v75, v75
    v_pk_add_f32 v[14:15], v[14:15], v[72:73]
    v_exp_f32 v76, v76
    v_exp_f32 v77, v77
    s_add_u32 m0, s15, 122880
    s_add_u32 s75, m0, s17
    buffer_load_dwordx4 v2, s[48:51], s75 offen offset:0 sc1 lds
    v_pk_add_f32 v[14:15], v[14:15], v[74:75]
    ds_write_b128 v32, v[136:139] offset:16
    v_exp_f32 v78, v78
    v_exp_f32_e64 v79, v79
    v_pk_add_f32 v[14:15], v[14:15], v[76:77]
    buffer_load_dwordx4 v2, s[48:51], s75 offen offset:1024 sc1 lds
    v_exp_f32 v80, v80
    v_exp_f32 v81, v81
    v_pk_add_f32 v[14:15], v[14:15], v[78:79]
    v_exp_f32 v82, v82
    v_exp_f32 v83, v83
    v_pk_add_f32 v[14:15], v[14:15], v[80:81]
    buffer_load_dwordx4 v2, s[48:51], s75 offen offset:2048 sc1 lds
    ds_write_b128 v32, v[140:143] offset:32
    v_exp_f32 v84, v84
    v_exp_f32 v85, v85
    v_pk_add_f32 v[14:15], v[14:15], v[82:83]
    v_exp_f32 v86, v86
    v_exp_f32 v87, v87
    buffer_load_dwordx4 v2, s[48:51], s75 offen offset:3072 sc1 lds
    v_pk_add_f32 v[14:15], v[14:15], v[84:85]
    s_waitcnt vmcnt(12)
    s_barrier
    s_cmp_lg_u32 s3, 0
    s_cbranch_scc1 L_pi_42
    s_mov_b32 s68, 28672
    buffer_load_dword v6, v26, s[48:51], s68 offen sc1
L_pi_42:
    ds_read_b64_tr_b16 a[184:185], v39 offset:0
    ds_read_b64_tr_b16 a[186:187], v39 offset:2560
    ds_read_b64_tr_b16 a[188:189], v40 offset:0
    ds_read_b64_tr_b16 a[190:191], v40 offset:2560
    ds_read_b64_tr_b16 a[192:193], v41 offset:0
    ds_read_b64_tr_b16 a[194:195], v41 offset:2560
    ds_read_b64_tr_b16 a[196:197], v42 offset:0
    ds_read_b64_tr_b16 a[198:199], v42 offset:2560
    ds_read_b64_tr_b16 a[200:201], v43 offset:0
    ds_read_b64_tr_b16 a[202:203], v43 offset:2560
    s_cmp_eq_u32 s73, 0
    s_cbranch_scc1 L_nz_44
    s_waitcnt lgkmcnt(0)
    s_mov_b32 exec_lo, 0xffff0000
    s_mov_b32 exec_hi, 0xffff0000
    s_nop 0
    v_accvgpr_write_b32 a186, 0
    v_accvgpr_write_b32 a187, 0
    v_accvgpr_write_b32 a190, 0
    v_accvgpr_write_b32 a191, 0
    v_accvgpr_write_b32 a194, 0
    v_accvgpr_write_b32 a195, 0
    v_accvgpr_write_b32 a198, 0
    v_accvgpr_write_b32 a199, 0
    v_accvgpr_write_b32 a202, 0
    v_accvgpr_write_b32 a203, 0
    s_mov_b64 exec, -1
L_nz_44:
    v_pk_add_f32 v[14:15], v[14:15], v[86:87]
    v_add_f32 v14, v14, v15
    v_rcp_f32 v14, v14
    s_nop 0
    v_pk_mul_f32 v[68:69], v[68:69], v[14:15] op_sel_hi:[1,0]
    v_pk_mul_f32 v[70:71], v[70:71], v[14:15] op_sel_hi:[1,0]
    v_cvt_pk_bf16_f32 v144, v68, v69
    v_pk_mul_f32 v[72:73], v[72:73], v[14:15] op_sel_hi:[1,0]
    v_cvt_pk_bf16_f32 v145, v70, v71
    v_pk_mul_f32 v[74:75], v[74:75], v[14:15] op_sel_hi:[1,0]
    v_cvt_pk_bf16_f32 v146, v72, v73
    v_pk_mul_f32 v[76:77], v[76:77], v[14:15] op_sel_hi:[1,0]
    v_cvt_pk_bf16_f32 v147, v74, v75
    v_pk_mul_f32 v[78:79], v[78:79], v[14:15] op_sel_hi:[1,0]
    v_cvt_pk_bf16_f32 v148, v76, v77
    s_waitcnt lgkmcnt(8)
    buffer_store_dwordx4 a[184:187], v38, s[48:51], s71 offen sc1
    s_add_u32 s71, s71, s13
    v_pk_mul_f32 v[80:81], v[80:81], v[14:15] op_sel_hi:[1,0]
    v_cvt_pk_bf16_f32 v149, v78, v79
    v_pk_mul_f32 v[82:83], v[82:83], v[14:15] op_sel_hi:[1,0]
    v_cvt_pk_bf16_f32 v150, v80, v81
    v_pk_mul_f32 v[84:85], v[84:85], v[14:15] op_sel_hi:[1,0]
    v_cvt_pk_bf16_f32 v151, v82, v83
    v_pk_mul_f32 v[86:87], v[86:87], v[14:15] op_sel_hi:[1,0]
    v_cvt_pk_bf16_f32 v152, v84, v85
    v_cvt_pk_bf16_f32 v153, v86, v87
    v_min3_f32 v12, v52, v53, v54
    v_min3_f32 v13, v55, v56, v57
    v_min3_f32 v12, v12, v58, v59
    v_min3_f32 v13, v13, v60, v61
    v_min3_f32 v12, v12, v62, v63
    v_min3_f32 v13, v13, v64, v65
    v_min3_f32 v12, v12, v66, v67
    v_min3_f32 v13, v13, v240, v241
    v_min3_f32 v12, v12, v242, v243
    v_min3_f32 v12, v12, v13, v13
    v_mul_f32 v13, s63, v12
    v_mov_b32 v12, s63
    s_waitcnt lgkmcnt(6)
    buffer_store_dwordx4 a[188:191], v38, s[48:51], s71 offen sc1
    s_add_u32 s71, s71, s13
    v_pk_fma_f32 v[68:69], v[52:53], v[12:13], v[12:13] op_sel:[0,0,1] op_sel_hi:[1,0,1] neg_lo:[0,1,0] neg_hi:[0,1,0]
    v_pk_fma_f32 v[70:71], v[54:55], v[12:13], v[12:13] op_sel:[0,0,1] op_sel_hi:[1,0,1] neg_lo:[0,1,0] neg_hi:[0,1,0]
    v_pk_fma_f32 v[72:73], v[56:57], v[12:13], v[12:13] op_sel:[0,0,1] op_sel_hi:[1,0,1] neg_lo:[0,1,0] neg_hi:[0,1,0]
    v_pk_fma_f32 v[74:75], v[58:59], v[12:13], v[12:13] op_sel:[0,0,1] op_sel_hi:[1,0,1] neg_lo:[0,1,0] neg_hi:[0,1,0]
    v_pk_fma_f32 v[76:77], v[60:61], v[12:13], v[12:13] op_sel:[0,0,1] op_sel_hi:[1,0,1] neg_lo:[0,1,0] neg_hi:[0,1,0]
    v_pk_fma_f32 v[78:79], v[62:63], v[12:13], v[12:13] op_sel:[0,0,1] op_sel_hi:[1,0,1] neg_lo:[0,1,0] neg_hi:[0,1,0]
    v_pk_fma_f32 v[80:81], v[64:65], v[12:13], v[12:13] op_sel:[0,0,1] op_sel_hi:[1,0,1] neg_lo:[0,1,0] neg_hi:[0,1,0]
    v_pk_fma_f32 v[82:83], v[66:67], v[12:13], v[12:13] op_sel:[0,0,1] op_sel_hi:[1,0,1] neg_lo:[0,1,0] neg_hi:[0,1,0]
    v_pk_fma_f32 v[84:85], v[240:241], v[12:13], v[12:13] op_sel:[0,0,1] op_sel_hi:[1,0,1] neg_lo:[0,1,0] neg_hi:[0,1,0]
    v_pk_fma_f32 v[86:87], v[242:243], v[12:13], v[12:13] op_sel:[0,0,1] op_sel_hi:[1,0,1] neg_lo:[0,1,0] neg_hi:[0,1,0]
    v_exp_f32 v68, v68
    v_exp_f32 v69, v69
    v_exp_f32 v70, v70
    v_exp_f32 v71, v71
    ds_write_b128 v32, v[144:147] offset:48
    s_waitcnt lgkmcnt(5)
    buffer_store_dwordx4 a[192:195], v38, s[48:51], s71 offen sc1
    s_add_u32 s71, s71, s13
    v_exp_f32 v72, v72
    v_exp_f32 v73, v73
    v_pk_add_f32 v[14:15], v[68:69], v[70:71]
    v_exp_f32 v74, v74
    v_exp_f32 v75, v75
    v_pk_add_f32 v[14:15], v[14:15], v[72:73]
    v_exp_f32 v76, v76
    v_exp_f32 v77, v77
    v_pk_add_f32 v[14:15], v[14:15], v[74:75]
    ds_write_b128 v32, v[148:151] offset:64
    v_exp_f32 v78, v78
    v_exp_f32 v79, v79
    s_waitcnt lgkmcnt(4)
    buffer_store_dwordx4 a[196:199], v38, s[48:51], s71 offen sc1
    s_add_u32 s71, s71, s13
    v_add_u32_e64 v38, s1, v2
    v_pk_add_f32 v[14:15], v[14:15], v[76:77]
    v_exp_f32 v80, v80
    v_exp_f32 v81, v81
    v_pk_add_f32 v[14:15], v[14:15], v[78:79]
    v_exp_f32 v82, v82
    v_exp_f32 v83, v83
    v_pk_add_f32 v[14:15], v[14:15], v[80:81]
    v_exp_f32 v84, v84
    v_exp_f32 v85, v85
    v_pk_add_f32 v[14:15], v[14:15], v[82:83]
    v_exp_f32 v86, v86
    v_exp_f32 v87, v87
    s_waitcnt lgkmcnt(2)
    buffer_store_dwordx4 a[200:203], v38, s[48:51], s71 offen sc1
    v_pk_add_f32 v[14:15], v[14:15], v[84:85]
    v_pk_add_f32 v[14:15], v[14:15], v[86:87]
    v_add_f32 v14, v14, v15
    v_rcp_f32 v14, v14
    s_nop 0
    v_pk_mul_f32 v[68:69], v[68:69], v[14:15] op_sel_hi:[1,0]
    v_pk_mul_f32 v[70:71], v[70:71], v[14:15] op_sel_hi:[1,0]
    v_cvt_pk_bf16_f32 v154, v68, v69
    v_pk_mul_f32 v[72:73], v[72:73], v[14:15] op_sel_hi:[1,0]
    v_cvt_pk_bf16_f32 v155, v70, v71
    ds_write_b128 v32, v[152:155] offset:80
    v_pk_mul_f32 v[74:75], v[74:75], v[14:15] op_sel_hi:[1,0]
    v_cvt_pk_bf16_f32 v156, v72, v73
    v_pk_mul_f32 v[76:77], v[76:77], v[14:15] op_sel_hi:[1,0]
    v_cvt_pk_bf16_f32 v157, v74, v75
    v_pk_mul_f32 v[78:79], v[78:79], v[14:15] op_sel_hi:[1,0]
    v_cvt_pk_bf16_f32 v158, v76, v77
    v_pk_mul_f32 v[80:81], v[80:81], v[14:15] op_sel_hi:[1,0]
    v_cvt_pk_bf16_f32 v159, v78, v79
    ds_write_b128 v32, v[156:159] offset:96
    v_pk_mul_f32 v[82:83], v[82:83], v[14:15] op_sel_hi:[1,0]
    v_cvt_pk_bf16_f32 v160, v80, v81
    v_pk_mul_f32 v[84:85], v[84:85], v[14:15] op_sel_hi:[1,0]
    v_cvt_pk_bf16_f32 v161, v82, v83
    v_pk_mul_f32 v[86:87], v[86:87], v[14:15] op_sel_hi:[1,0]
    v_cvt_pk_bf16_f32 v162, v84, v85
    v_cvt_pk_bf16_f32 v163, v86, v87
    ds_write_b128 v32, v[160:163] offset:112
    s_waitcnt vmcnt(5)
    s_waitcnt lgkmcnt(0)
    s_cmp_lg_u32 s3, 0
    s_cbranch_scc1 L_ok_46
    v_cmp_gt_u32 vcc, 16, v6
    s_cbranch_vccz L_ok_46
    s_mov_b32 s70, 0
L_spin_47:
    buffer_load_dword v6, v26, s[48:51], s68 offen sc1
    s_add_u32 s70, s70, 1
    s_waitcnt vmcnt(0)
    v_cmp_gt_u32 vcc, 16, v6
    s_cmp_lt_u32 s70, 65536
    s_cselect_b64 vcc, vcc, 0
    s_cbranch_vccnz L_spin_47
L_ok_46:
    s_barrier
    s_nop 0
    v_add_u32 v11, 102400, v2
    ds_read_b64_tr_b16 v[176:177], v33 offset:0
    ds_read_b64_tr_b16 v[178:179], v33 offset:144
    ds_read_b64_tr_b16 v[180:181], v34 offset:0
    ds_read_b64_tr_b16 v[182:183], v34 offset:144
    ds_read_b64_tr_b16 v[184:185], v33 offset:2304
    ds_read_b64_tr_b16 v[186:187], v33 offset:2448
    ds_read_b64_tr_b16 v[188:189], v34 offset:2304
    ds_read_b64_tr_b16 v[190:191], v34 offset:2448
    ds_read_b64_tr_b16 v[192:193], v33 offset:4608
    ds_read_b64_tr_b16 v[194:195], v33 offset:4752
    ds_read_b64_tr_b16 v[196:197], v34 offset:4608
    ds_read_b64_tr_b16 v[198:199], v34 offset:4752
    s_waitcnt lgkmcnt(8)
    v_mfma_f32_32x32x16_bf16 v[52:67], v[176:179], v[180:183], 0
    ds_read_b64_tr_b16 v[200:201], v33 offset:6912
    ds_read_b64_tr_b16 v[202:203], v33 offset:7056
    ds_read_b64_tr_b16 v[204:205], v34 offset:6912
    ds_read_b64_tr_b16 v[206:207], v34 offset:7056
    s_waitcnt lgkmcnt(8)
    v_mfma_f32_32x32x16_bf16 v[52:67], v[184:187], v[188:191], v[52:67]
    ds_read_b64_tr_b16 v[208:209], v33 offset:9216
    ds_read_b64_tr_b16 v[210:211], v33 offset:9360
    ds_read_b64_tr_b16 v[212:213], v34 offset:9216
    ds_read_b64_tr_b16 v[214:215], v34 offset:9360
    s_waitcnt lgkmcnt(8)
    v_mfma_f32_32x32x16_bf16 v[52:67], v[192:195], v[196:199], v[52:67]
    ds_read_b64_tr_b16 v[84:85], v33 offset:11520
    ds_read_b64_tr_b16 v[86:87], v33 offset:11664
    ds_read_b64_tr_b16 v[88:89], v34 offset:11520
    ds_read_b64_tr_b16 v[90:91], v34 offset:11664
    s_waitcnt lgkmcnt(8)
    v_mfma_f32_32x32x16_bf16 v[52:67], v[200:203], v[204:207], v[52:67]
    ds_read_b64_tr_b16 v[92:93], v33 offset:13824
    ds_read_b64_tr_b16 v[94:95], v33 offset:13968
    ds_read_b64_tr_b16 v[96:97], v34 offset:13824
    ds_read_b64_tr_b16 v[98:99], v34 offset:13968
    s_waitcnt lgkmcnt(8)
    v_mfma_f32_32x32x16_bf16 v[52:67], v[208:211], v[212:215], v[52:67]
    ds_read_b64_tr_b16 v[100:101], v33 offset:16128
    ds_read_b64_tr_b16 v[102:103], v33 offset:16272
    ds_read_b64_tr_b16 v[104:105], v34 offset:16128
    ds_read_b64_tr_b16 v[106:107], v34 offset:16272
    s_waitcnt lgkmcnt(8)
    v_mfma_f32_32x32x16_bf16 v[52:67], v[84:87], v[88:91], v[52:67]
    s_waitcnt lgkmcnt(4)
    v_mfma_f32_32x32x16_bf16 v[52:67], v[92:95], v[96:99], v[52:67]
    ds_read_b128 v[132:135], v11 offset:12288
    ds_read_b128 v[136:139], v11 offset:13312
    ds_read_b128 v[140:143], v11 offset:14336
    s_waitcnt lgkmcnt(3)
    v_mfma_f32_32x32x16_bf16 v[52:67], v[100:103], v[104:107], v[52:67]
    ds_read_b128 v[144:147], v11 offset:15360
    ds_read_b128 v[148:151], v11 offset:16384
    ds_read_b128 v[152:155], v11 offset:17408
    s_nop 8
    v_cvt_pk_bf16_f32 v72, v52, v53
    v_cvt_pk_bf16_f32 v73, v54, v55
    v_cvt_pk_bf16_f32 v74, v56, v57
    s_nop 0
    v_cvt_pk_bf16_f32 v75, v58, v59
    buffer_store_dwordx4 v[72:75], v35, s[48:51], s64 offen sc1
    v_cvt_pk_bf16_f32 v76, v60, v61
    v_cvt_pk_bf16_f32 v77, v62, v63
    v_cvt_pk_bf16_f32 v78, v64, v65
    v_cvt_pk_bf16_f32 v79, v66, v67
    buffer_store_dwordx4 v[76:79], v36, s[48:51], s64 offen offset:768 sc1
    s_cmp_lg_u32 s3, 1
    s_cbranch_scc1 L_nopf_49
    s_getpc_b64 s[56:57]
L_pc_50:
    s_and_b32 s56, s56, 0xffffff00
    s_mov_b32 s58, L_end-L_pc_50
    s_mov_b32 s59, 0x20000
    s_lshr_b32 s10, s2, 3
    s_lshl_b32 s10, s10, 10
    v_lshlrev_b32 v6, 4, v1
    v_add_u32 v6, s10, v6
    buffer_load_dword v6, v6, s[56:59], 0 offen
L_nopf_49:
    s_waitcnt lgkmcnt(4)
    v_mfma_f32_16x16x32_bf16 v[216:219], v[132:135], a[24:27], 0
    s_mul_i32 s15, s3, 3072
    s_add_u32 m0, s15, 102400
    v_mfma_f32_16x16x32_bf16 v[228:231], v[132:135], a[28:31], 0
    ds_read_b128 v[156:159], v11 offset:18432
    s_add_u32 s75, m0, s16
    v_mfma_f32_16x16x32_bf16 v[220:223], v[136:139], a[24:27], 0
    s_add_u32 s75, s75, 49152
    v_and_b32 v7, 0xcf, v0
    v_mfma_f32_16x16x32_bf16 v[232:235], v[136:139], a[28:31], 0
    ds_read_b128 v[160:163], v11 offset:19456
    s_waitcnt lgkmcnt(4)
    v_mfma_f32_16x16x32_bf16 v[224:227], v[140:143], a[24:27], 0
    buffer_load_dwordx4 v2, s[48:51], s75 offen offset:0 sc1 lds
    v_mfma_f32_16x16x32_bf16 v[236:239], v[140:143], a[28:31], 0
    ds_read_b128 v[132:135], v11 offset:20480
    v_lshrrev_b32 v8, 4, v1
    v_mfma_f32_16x16x32_bf16 v[216:219], v[144:147], a[32:35], v[216:219]
    v_mul_u32_u24 v9, 3840, v8
    v_lshl_add_u32 v31, v7, 4, v9
    v_mfma_f32_16x16x32_bf16 v[228:231], v[144:147], a[36:39], v[228:231]
    ds_read_b128 v[136:139], v11 offset:21504
    s_waitcnt lgkmcnt(4)
    v_mfma_f32_16x16x32_bf16 v[220:223], v[148:151], a[32:35], v[220:223]
    buffer_load_dwordx4 v2, s[48:51], s75 offen offset:1024 sc1 lds
    v_mfma_f32_16x16x32_bf16 v[232:235], v[148:151], a[36:39], v[232:235]
    ds_read_b128 v[140:143], v11 offset:22528
    v_mov_b32 v9, 1073741824
    v_mfma_f32_16x16x32_bf16 v[224:227], v[152:155], a[32:35], v[224:227]
    v_cmp_gt_u32 vcc, 192, v7
    v_lshl_add_u32 v10, v20, 4, v7
    v_mfma_f32_16x16x32_bf16 v[236:239], v[152:155], a[36:39], v[236:239]
    ds_read_b128 v[144:147], v11 offset:23552
    s_waitcnt lgkmcnt(4)
    v_mfma_f32_16x16x32_bf16 v[216:219], v[156:159], a[40:43], v[216:219]
    buffer_load_dwordx4 v2, s[48:51], s75 offen offset:2048 sc1 lds
    v_mfma_f32_16x16x32_bf16 v[228:231], v[156:159], a[44:47], v[228:231]
    ds_read_b128 v[148:151], v11 offset:24576
    v_and_b32 v8, 1, v8
    v_mfma_f32_16x16x32_bf16 v[220:223], v[160:163], a[40:43], v[220:223]
    v_cndmask_b32 v32, v9, v31, vcc
    v_lshl_add_u32 v10, v10, 1, v8
    v_mfma_f32_16x16x32_bf16 v[232:235], v[160:163], a[44:47], v[232:235]
    ds_read_b128 v[152:155], v11 offset:25600
    s_waitcnt lgkmcnt(4)
    v_mfma_f32_16x16x32_bf16 v[224:227], v[132:135], a[40:43], v[224:227]
    v_lshlrev_b32 v10, 3, v10
    v_add_u32 v30, 102400, v10
    v_mfma_f32_16x16x32_bf16 v[236:239], v[132:135], a[44:47], v[236:239]
    ds_read_b128 v[156:159], v11 offset:26624
    v_and_b32 v7, 1, v1
    v_mfma_f32_16x16x32_bf16 v[216:219], v[136:139], a[48:51], v[216:219]
    v_lshlrev_b32 v7, 4, v7
    v_lshlrev_b32 v7, v7, v4
    v_mfma_f32_16x16x32_bf16 v[228:231], v[136:139], a[52:55], v[228:231]
    ds_read_b128 v[160:163], v11 offset:27648
    s_waitcnt lgkmcnt(4)
    v_mfma_f32_16x16x32_bf16 v[220:223], v[140:143], a[48:51], v[220:223]
    v_mul_u32_u24 v7, 0x3f80, v7
    v_bfe_u32 v8, v1, 1, 3
    v_mfma_f32_16x16x32_bf16 v[232:235], v[140:143], a[52:55], v[232:235]
    ds_read_b128 v[132:135], v11 offset:28672
    v_cmp_eq_u32 vcc, 0, v8
    v_mfma_f32_16x16x32_bf16 v[224:227], v[144:147], a[48:51], v[224:227]
    s_nop 0
    v_cndmask_b32 v9, v5, v7, vcc
    v_cmp_eq_u32 vcc, 1, v8
    v_mfma_f32_16x16x32_bf16 v[236:239], v[144:147], a[52:55], v[236:239]
    ds_read_b128 v[136:139], v11 offset:29696
    s_waitcnt lgkmcnt(4)
    v_mfma_f32_16x16x32_bf16 v[216:219], v[148:151], a[56:59], v[216:219]
    buffer_load_dwordx4 a[24:27], v2, s[48:51], s24 offen offset:0 sc1
    v_mfma_f32_16x16x32_bf16 v[228:231], v[148:151], a[60:63], v[228:231]
    ds_read_b128 v[140:143], v11 offset:30720
    v_accvgpr_write_b32 a184, v9
    v_mfma_f32_16x16x32_bf16 v[220:223], v[152:155], a[56:59], v[220:223]
    v_cndmask_b32 v9, v5, v7, vcc
    v_cmp_eq_u32 vcc, 2, v8
    v_mfma_f32_16x16x32_bf16 v[232:235], v[152:155], a[60:63], v[232:235]
    ds_read_b128 v[144:147], v11 offset:31744
    s_waitcnt lgkmcnt(4)
    v_mfma_f32_16x16x32_bf16 v[224:227], v[156:159], a[56:59], v[224:227]
    buffer_load_dwordx4 a[28:31], v2, s[48:51], s24 offen offset:1024 sc1
    v_mfma_f32_16x16x32_bf16 v[236:239], v[156:159], a[60:63], v[236:239]
    ds_read_b128 v[148:151], v11 offset:32768
    v_accvgpr_write_b32 a185, v9
    v_mfma_f32_16x16x32_bf16 v[216:219], v[160:163], a[64:67], v[216:219]
    v_cndmask_b32 v9, v5, v7, vcc
    v_cmp_eq_u32 vcc, 3, v8
    v_mfma_f32_16x16x32_bf16 v[228:231], v[160:163], a[68:71], v[228:231]
    ds_read_b128 v[152:155], v11 offset:33792
    s_waitcnt lgkmcnt(4)
    v_mfma_f32_16x16x32_bf16 v[220:223], v[132:135], a[64:67], v[220:223]
    buffer_load_dwordx4 a[32:35], v2, s[48:51], s24 offen offset:2048 sc1
    v_mfma_f32_16x16x32_bf16 v[232:235], v[132:135], a[68:71], v[232:235]
    ds_read_b128 v[156:159], v11 offset:34816
    v_accvgpr_write_b32 a186, v9
    v_mfma_f32_16x16x32_bf16 v[224:227], v[136:139], a[64:67], v[224:227]
    v_cndmask_b32 v9, v5, v7, vcc
    v_cmp_eq_u32 vcc, 4, v8
    v_mfma_f32_16x16x32_bf16 v[236:239], v[136:139], a[68:71], v[236:239]
    ds_read_b128 v[160:163], v11 offset:35840
    s_waitcnt lgkmcnt(4)
    v_mfma_f32_16x16x32_bf16 v[216:219], v[140:143], a[72:75], v[216:219]
    buffer_load_dwordx4 a[36:39], v2, s[48:51], s24 offen offset:3072 sc1
    s_add_u32 s24, s24, 4096
    v_mfma_f32_16x16x32_bf16 v[228:231], v[140:143], a[76:79], v[228:231]
    ds_read_b128 v[132:135], v11 offset:36864
    v_accvgpr_write_b32 a187, v9
    v_mfma_f32_16x16x32_bf16 v[220:223], v[144:147], a[72:75], v[220:223]
    v_cndmask_b32 v9, v5, v7, vcc
    v_cmp_eq_u32 vcc, 5, v8
    v_mfma_f32_16x16x32_bf16 v[232:235], v[144:147], a[76:79], v[232:235]
    ds_read_b128 v[136:139], v11 offset:37888
    s_waitcnt lgkmcnt(4)
    v_mfma_f32_16x16x32_bf16 v[224:227], v[148:151], a[72:75], v[224:227]
    buffer_load_dwordx4 a[40:43], v2, s[48:51], s24 offen offset:0 sc1
    v_mfma_f32_16x16x32_bf16 v[236:239], v[148:151], a[76:79], v[236:239]
    ds_read_b128 v[140:143], v11 offset:38912
    v_accvgpr_write_b32 a188, v9
    v_mfma_f32_16x16x32_bf16 v[216:219], v[152:155], a[80:83], v[216:219]
    v_cndmask_b32 v9, v5, v7, vcc
    v_cmp_eq_u32 vcc, 6, v8
    v_mfma_f32_16x16x32_bf16 v[228:231], v[152:155], a[84:87], v[228:231]
    ds_read_b128 v[144:147], v11 offset:39936
    s_waitcnt lgkmcnt(4)
    v_mfma_f32_16x16x32_bf16 v[220:223], v[156:159], a[80:83], v[220:223]
    v_accvgpr_write_b32 a189, v9
    v_cndmask_b32 v9, v5, v7, vcc
    v_mfma_f32_16x16x32_bf16 v[232:235], v[156:159], a[84:87], v[232:235]
    ds_read_b128 v[148:151], v11 offset:40960
    v_cmp_eq_u32 vcc, 7, v8
    v_mfma_f32_16x16x32_bf16 v[224:227], v[160:163], a[80:83], v[224:227]
    v_accvgpr_write_b32 a190, v9
    v_cndmask_b32 v9, v5, v7, vcc
    v_mfma_f32_16x16x32_bf16 v[236:239], v[160:163], a[84:87], v[236:239]
    ds_read_b128 v[152:155], v11 offset:41984
    s_waitcnt lgkmcnt(4)
    v_mfma_f32_16x16x32_bf16 v[216:219], v[132:135], a[88:91], v[216:219]
    v_accvgpr_write_b32 a191, v9
    v_bfe_u32 v7, v1, 3, 2
    v_mfma_f32_16x16x32_bf16 v[228:231], v[132:135], a[92:95], v[228:231]
    s_waitcnt vmcnt(5)
    s_barrier
    s_cmp_lg_u32 s3, 0
    s_cbranch_scc1 L_sig_52
    s_mov_b64 exec, 1
    s_add_u32 s10, s5, 48
    s_lshl_b32 s10, s10, 8
    buffer_atomic_add v4, v5, s[48:51], s10 offen sc1
    s_mov_b64 exec, 1
    s_add_u32 s10, s5, 32
    s_lshl_b32 s10, s10, 8
    buffer_atomic_add v4, v5, s[48:51], s10 offen sc1
    s_mov_b64 exec, -1
L_sig_52:
    ds_read_b128 v[156:159], v11 offset:43008
    v_and_b32 v8, 3, v1
    v_mfma_f32_16x16x32_bf16 v[220:223], v[136:139], a[88:91], v[220:223]
    buffer_load_dwordx4 a[44:47], v2, s[48:51], s24 offen offset:1024 sc1
    v_mfma_f32_16x16x32_bf16 v[232:235], v[136:139], a[92:95], v[232:235]
    ds_read_b128 v[160:163], v11 offset:44032
    s_waitcnt lgkmcnt(4)
    v_mfma_f32_16x16x32_bf16 v[224:227], v[140:143], a[88:91], v[224:227]
    v_lshl_add_u32 v7, v7, 2, v8
    v_mul_u32_u24 v8, 120, v20
    v_mfma_f32_16x16x32_bf16 v[236:239], v[140:143], a[92:95], v[236:239]
    ds_read_b128 v[132:135], v11 offset:45056
    v_add_lshl_u32 v8, v8, v7, 4
    v_mfma_f32_16x16x32_bf16 v[216:219], v[144:147], a[96:99], v[216:219]
    buffer_load_dwordx4 a[48:51], v2, s[48:51], s24 offen offset:2048 sc1
    v_mfma_f32_16x16x32_bf16 v[228:231], v[144:147], a[100:103], v[228:231]
    ds_read_b128 v[136:139], v11 offset:46080
    s_waitcnt lgkmcnt(4)
    v_mfma_f32_16x16x32_bf16 v[220:223], v[148:151], a[96:99], v[220:223]
    v_add_u32 v8, 102400, v8
    v_cmp_gt_u32 vcc, 8, v7
    v_mfma_f32_16x16x32_bf16 v[232:235], v[148:151], a[100:103], v[232:235]
    ds_read_b128 v[140:143], v11 offset:47104
    v_add_u32 v10, 256, v8
    v_mfma_f32_16x16x32_bf16 v[224:227], v[152:155], a[96:99], v[224:227]
    buffer_load_dwordx4 a[52:55], v2, s[48:51], s24 offen offset:3072 sc1
    s_add_u32 s24, s24, 4096
    v_mfma_f32_16x16x32_bf16 v[236:239], v[152:155], a[100:103], v[236:239]
    ds_read_b128 v[144:147], v11 offset:48128
    s_waitcnt lgkmcnt(4)
    v_mfma_f32_16x16x32_bf16 v[216:219], v[156:159], a[104:107], v[216:219]
    v_mov_b32 v9, 102768
    v_cndmask_b32 v10, v9, v10, vcc
    v_mfma_f32_16x16x32_bf16 v[228:231], v[156:159], a[108:111], v[228:231]
    ds_read_b128 v[148:151], v11 offset:49152
    s_mov_b32 vcc_lo, 0x0f0f0f0f
    v_mfma_f32_16x16x32_bf16 v[220:223], v[160:163], a[104:107], v[220:223]
    buffer_load_dwordx4 a[56:59], v2, s[48:51], s24 offen offset:0 sc1
    v_mfma_f32_16x16x32_bf16 v[232:235], v[160:163], a[108:111], v[232:235]
    ds_read_b128 v[152:155], v11 offset:50176
    s_waitcnt lgkmcnt(4)
    v_mfma_f32_16x16x32_bf16 v[224:227], v[132:135], a[104:107], v[224:227]
    s_mov_b32 vcc_hi, 0xf0f0f0f0
    v_cndmask_b32 v27, v9, v8, vcc
    v_mfma_f32_16x16x32_bf16 v[236:239], v[132:135], a[108:111], v[236:239]
    ds_read_b128 v[156:159], v11 offset:51200
    v_cndmask_b32 v28, v9, v10, vcc
    v_mfma_f32_16x16x32_bf16 v[216:219], v[136:139], a[112:115], v[216:219]
    buffer_load_dwordx4 a[60:63], v2, s[48:51], s24 offen offset:1024 sc1
    v_mfma_f32_16x16x32_bf16 v[228:231], v[136:139], a[116:119], v[228:231]
    ds_read_b128 v[160:163], v11 offset:52224
    s_waitcnt lgkmcnt(4)
    v_mfma_f32_16x16x32_bf16 v[220:223], v[140:143], a[112:115], v[220:223]
    v_bfe_u32 v7, v1, 4, 1
    v_mul_u32_u24 v7, 20480, v7
    v_mfma_f32_16x16x32_bf16 v[232:235], v[140:143], a[116:119], v[232:235]
    ds_read_b128 v[132:135], v11 offset:53248
    v_and_b32 v8, 15, v1
    v_mfma_f32_16x16x32_bf16 v[224:227], v[144:147], a[112:115], v[224:227]
    buffer_load_dwordx4 a[64:67], v2, s[48:51], s24 offen offset:2048 sc1
    v_mfma_f32_16x16x32_bf16 v[236:239], v[144:147], a[116:119], v[236:239]
    ds_read_b128 v[136:139], v11 offset:54272
    s_waitcnt lgkmcnt(4)
    v_mfma_f32_16x16x32_bf16 v[216:219], v[148:151], a[120:123], v[216:219]
    v_lshl_add_u32 v7, v8, 4, v7
    v_lshl_add_u32 v29, v20, 11, v7
    v_mfma_f32_16x16x32_bf16 v[228:231], v[148:151], a[124:127], v[228:231]
    ds_read_b128 v[140:143], v11 offset:55296
    s_lshl_b32 s64, s4, 2
    v_mfma_f32_16x16x32_bf16 v[220:223], v[152:155], a[120:123], v[220:223]
    buffer_load_dwordx4 a[68:71], v2, s[48:51], s24 offen offset:3072 sc1
    s_add_u32 s24, s24, 4096
    v_mfma_f32_16x16x32_bf16 v[232:235], v[152:155], a[124:127], v[232:235]
    ds_read_b128 v[144:147], v11 offset:56320
    s_waitcnt lgkmcnt(4)
    v_mfma_f32_16x16x32_bf16 v[224:227], v[156:159], a[120:123], v[224:227]
    s_add_u32 s64, s64, s3
    s_mul_i32 s64, s64, 40960
    v_mfma_f32_16x16x32_bf16 v[236:239], v[156:159], a[124:127], v[236:239]
    ds_read_b128 v[148:151], v11 offset:57344
    s_lshr_b32 s11, s5, 2
    v_mfma_f32_16x16x32_bf16 v[216:219], v[160:163], a[128:131], v[216:219]
    buffer_load_dwordx4 a[72:75], v2, s[48:51], s24 offen offset:0 sc1
    v_mfma_f32_16x16x32_bf16 v[228:231], v[160:163], a[132:135], v[228:231]
    ds_read_b128 v[152:155], v11 offset:58368
    s_waitcnt lgkmcnt(4)
    v_mfma_f32_16x16x32_bf16 v[220:223], v[132:135], a[128:131], v[220:223]
    s_mul_i32 s11, s11, 5120
    s_add_u32 s64, s64, s11
    v_mfma_f32_16x16x32_bf16 v[232:235], v[132:135], a[132:135], v[232:235]
    ds_read_b128 v[156:159], v11 offset:59392
    s_and_b32 s11, s5, 3
    v_mfma_f32_16x16x32_bf16 v[224:227], v[136:139], a[128:131], v[224:227]
    buffer_load_dwordx4 a[76:79], v2, s[48:51], s24 offen offset:1024 sc1
    v_mfma_f32_16x16x32_bf16 v[236:239], v[136:139], a[132:135], v[236:239]
    ds_read_b128 v[160:163], v11 offset:60416
    s_waitcnt lgkmcnt(4)
    v_mfma_f32_16x16x32_bf16 v[216:219], v[140:143], a[136:139], v[216:219]
    s_lshl_b32 s11, s11, 8
    s_add_u32 s64, s64, s11
    v_mfma_f32_16x16x32_bf16 v[228:231], v[140:143], a[140:143], v[228:231]
    ds_read_b128 v[132:135], v11 offset:0
    s_add_u32 s64, s64, 3932160
    v_mfma_f32_16x16x32_bf16 v[220:223], v[144:147], a[136:139], v[220:223]
    s_cmp_lg_u32 s3, 0
    s_cbranch_scc1 L_pi_54
    s_add_u32 s68, s5, 48
    s_lshl_b32 s68, s68, 8
    s_mov_b64 exec, 1
    v_mov_b32 v6, 0
    buffer_atomic_add v6, v5, s[48:51], s68 offen sc0 sc1
    s_mov_b64 exec, -1
L_pi_54:
    v_mfma_f32_16x16x32_bf16 v[232:235], v[144:147], a[140:143], v[232:235]
    ds_read_b128 v[136:139], v11 offset:1024
    s_waitcnt lgkmcnt(4)
    v_mfma_f32_16x16x32_bf16 v[224:227], v[148:151], a[136:139], v[224:227]
    s_add_u32 s69, s64, 4096
    s_lshr_b32 s1, s6, 1
    v_mfma_f32_16x16x32_bf16 v[236:239], v[148:151], a[140:143], v[236:239]
    ds_read_b128 v[140:143], v11 offset:2048
    v_mul_f32 v108, v23, v120
    v_mfma_f32_16x16x32_bf16 v[216:219], v[152:155], a[144:147], v[216:219]
    buffer_load_dwordx4 a[80:83], v2, s[48:51], s24 offen offset:2048 sc1
    v_mfma_f32_16x16x32_bf16 v[228:231], v[152:155], a[148:151], v[228:231]
    ds_read_b128 v[144:147], v11 offset:3072
    s_waitcnt lgkmcnt(4)
    v_mfma_f32_16x16x32_bf16 v[220:223], v[156:159], a[144:147], v[220:223]
    v_mul_f32 v120, v25, v120
    v_mul_f32 v109, v23, v121
    v_mfma_f32_16x16x32_bf16 v[232:235], v[156:159], a[148:151], v[232:235]
    ds_read_b128 v[148:151], v11 offset:4096
    v_mul_f32 v121, v25, v121
    v_mfma_f32_16x16x32_bf16 v[224:227], v[160:163], a[144:147], v[224:227]
    buffer_load_dwordx4 a[84:87], v2, s[48:51], s24 offen offset:3072 sc1
    s_add_u32 s24, s24, 4096
    v_mfma_f32_16x16x32_bf16 v[236:239], v[160:163], a[148:151], v[236:239]
    ds_read_b128 v[152:155], v11 offset:5120
    s_waitcnt lgkmcnt(4)
    v_mfma_f32_16x16x32_bf16 v[216:219], v[132:135], a[152:155], v[216:219]
    v_mul_f32 v110, v23, v122
    v_mul_f32 v122, v25, v122
    v_mfma_f32_16x16x32_bf16 v[228:231], v[132:135], a[156:159], v[228:231]
    ds_read_b128 v[156:159], v11 offset:6144
    v_mul_f32 v111, v23, v123
    v_mfma_f32_16x16x32_bf16 v[220:223], v[136:139], a[152:155], v[220:223]
    buffer_load_dwordx4 a[88:91], v2, s[48:51], s24 offen offset:0 sc1
    v_mfma_f32_16x16x32_bf16 v[232:235], v[136:139], a[156:159], v[232:235]
    ds_read_b128 v[160:163], v11 offset:7168
    s_waitcnt lgkmcnt(4)
    v_mfma_f32_16x16x32_bf16 v[224:227], v[140:143], a[152:155], v[224:227]
    v_mul_f32 v123, v25, v123
    v_mul_f32 v112, v23, v124
    v_mfma_f32_16x16x32_bf16 v[236:239], v[140:143], a[156:159], v[236:239]
    ds_read_b128 v[132:135], v11 offset:8192
    v_mul_f32 v124, v25, v124
    v_mfma_f32_16x16x32_bf16 v[216:219], v[144:147], a[160:163], v[216:219]
    buffer_load_dwordx4 a[92:95], v2, s[48:51], s24 offen offset:1024 sc1
    v_mfma_f32_16x16x32_bf16 v[228:231], v[144:147], a[164:167], v[228:231]
    ds_read_b128 v[136:139], v11 offset:9216
    s_waitcnt lgkmcnt(4)
    v_mfma_f32_16x16x32_bf16 v[220:223], v[148:151], a[160:163], v[220:223]
    v_mul_f32 v113, v23, v125
    v_mul_f32 v125, v25, v125
    v_mfma_f32_16x16x32_bf16 v[232:235], v[148:151], a[164:167], v[232:235]
    ds_read_b128 v[140:143], v11 offset:10240
    v_mul_f32 v114, v23, v126
    v_mfma_f32_16x16x32_bf16 v[224:227], v[152:155], a[160:163], v[224:227]
    buffer_load_dwordx4 a[96:99], v2, s[48:51], s24 offen offset:2048 sc1
    v_mfma_f32_16x16x32_bf16 v[236:239], v[152:155], a[164:167], v[236:239]
    ds_read_b128 v[144:147], v11 offset:11264
    s_waitcnt lgkmcnt(4)
    v_mfma_f32_16x16x32_bf16 v[216:219], v[156:159], a[168:171], v[216:219]
    v_mul_f32 v126, v25, v126
    v_mul_f32 v115, v23, v127
    v_mfma_f32_16x16x32_bf16 v[228:231], v[156:159], a[172:175], v[228:231]
    v_mul_f32 v127, v25, v127
    v_mul_f32 v116, v23, v128
    v_mfma_f32_16x16x32_bf16 v[220:223], v[160:163], a[168:171], v[220:223]
    buffer_load_dwordx4 a[100:103], v2, s[48:51], s24 offen offset:3072 sc1
    s_add_u32 s24, s24, 4096
    v_mfma_f32_16x16x32_bf16 v[232:235], v[160:163], a[172:175], v[232:235]
    v_mul_f32 v128, v25, v128
    s_waitcnt lgkmcnt(2)
    v_mfma_f32_16x16x32_bf16 v[224:227], v[132:135], a[168:171], v[224:227]
    v_mul_f32 v117, v23, v129
    v_mul_f32 v129, v25, v129
    v_mfma_f32_16x16x32_bf16 v[236:239], v[132:135], a[172:175], v[236:239]
    v_mul_f32 v118, v23, v130
    v_mul_f32 v130, v25, v130
    v_mfma_f32_16x16x32_bf16 v[216:219], v[136:139], a[176:179], v[216:219]
    v_mul_f32 v119, v23, v131
    v_mul_f32 v131, v25, v131
    v_mfma_f32_16x16x32_bf16 v[228:231], v[136:139], a[180:183], v[228:231]
    s_waitcnt lgkmcnt(0)
    v_mfma_f32_16x16x32_bf16 v[220:223], v[140:143], a[176:179], v[220:223]
    v_mfma_f32_16x16x32_bf16 v[232:235], v[140:143], a[180:183], v[232:235]
    v_mfma_f32_16x16x32_bf16 v[224:227], v[144:147], a[176:179], v[224:227]
    v_mfma_f32_16x16x32_bf16 v[236:239], v[144:147], a[180:183], v[236:239]
    s_cmp_lg_u32 s3, 0
    s_cbranch_scc1 L_ok_56
    s_mov_b64 exec, 1
    s_waitcnt vmcnt(6)
    v_cmp_gt_u32 vcc, 16, v6
    s_cbranch_vccz L_pd_59
    s_mov_b32 s70, 0
L_spin_57:
    v_mov_b32 v6, 0
    buffer_atomic_add v6, v5, s[48:51], s68 offen sc0 sc1
    s_add_u32 s70, s70, 1
    s_waitcnt vmcnt(0)
    v_cmp_gt_u32 vcc, 16, v6
    s_cmp_lt_u32 s70, 65536
    s_cselect_b64 vcc, vcc, 0
    s_cbranch_vccnz L_spin_57
L_pd_59:
    s_mov_b64 exec, -1
L_ok_56:
    s_barrier
    buffer_load_dwordx4 a[104:107], v31, s[48:51], s65 offen offset:0 sc1
    buffer_load_dwordx4 a[108:111], v31, s[48:51], s65 offen offset:256 sc1
    buffer_load_dwordx4 a[112:115], v31, s[48:51], s65 offen offset:512 sc1
    buffer_load_dwordx4 a[116:119], v32, s[48:51], s65 offen offset:768 sc1
    s_add_u32 s65, s65, 15360
    v_pk_fma_f32 v[216:217], v[216:217], v[22:23], v[108:109] op_sel_hi:[1,0,1]
    v_pk_fma_f32 v[218:219], v[218:219], v[22:23], v[110:111] op_sel_hi:[1,0,1]
    v_pk_fma_f32 v[220:221], v[220:221], v[22:23], v[112:113] op_sel_hi:[1,0,1]
    v_pk_fma_f32 v[222:223], v[222:223], v[22:23], v[114:115] op_sel_hi:[1,0,1]
    v_pk_fma_f32 v[224:225], v[224:225], v[22:23], v[116:117] op_sel_hi:[1,0,1]
    v_pk_fma_f32 v[226:227], v[226:227], v[22:23], v[118:119] op_sel_hi:[1,0,1]
    v_pk_fma_f32 v[228:229], v[228:229], v[24:25], v[120:121] op_sel_hi:[1,0,1]
    v_pk_fma_f32 v[230:231], v[230:231], v[24:25], v[122:123] op_sel_hi:[1,0,1]
    v_pk_fma_f32 v[232:233], v[232:233], v[24:25], v[124:125] op_sel_hi:[1,0,1]
    v_pk_fma_f32 v[234:235], v[234:235], v[24:25], v[126:127] op_sel_hi:[1,0,1]
    v_pk_fma_f32 v[236:237], v[236:237], v[24:25], v[128:129] op_sel_hi:[1,0,1]
    v_pk_fma_f32 v[238:239], v[238:239], v[24:25], v[130:131] op_sel_hi:[1,0,1]
    v_cvt_pk_bf16_f32 v164, v216, v217
    v_cvt_pk_bf16_f32 v166, v228, v229
    v_cvt_pk_bf16_f32 v165, v218, v219
    v_cvt_pk_bf16_f32 v167, v230, v231
    v_permlane16_swap_b32 v164, v166
    s_nop 0
    v_permlane16_swap_b32 v165, v167
    s_nop 1
    v_mfma_f32_32x32x16_bf16 v[52:67], a[0:3], v[164:167], 0
    buffer_load_dwordx4 a[120:123], v31, s[48:51], s65 offen offset:0 sc1
    s_mul_i32 s66, s3, 3584
    s_add_u32 s66, s66, 107520
    s_lshl_b32 s67, s6, 2
    s_add_u32 s67, s67, s3
    s_mul_i32 s67, s67, 20480
    v_mfma_f32_32x32x16_bf16 v[240:255], a[12:15], v[164:167], 0
    v_cvt_pk_bf16_f32 v168, v220, v221
    v_cvt_pk_bf16_f32 v170, v232, v233
    v_cvt_pk_bf16_f32 v169, v222, v223
    v_cvt_pk_bf16_f32 v171, v234, v235
    v_permlane16_swap_b32 v168, v170
    s_nop 0
    v_permlane16_swap_b32 v169, v171
    s_nop 1
    v_mfma_f32_32x32x16_bf16 v[52:67], a[4:7], v[168:171], v[52:67]
    buffer_load_dwordx4 a[124:127], v31, s[48:51], s65 offen offset:256 sc1
    s_mul_i32 s11, s7, 160
    s_add_u32 s67, s67, s11
    s_mul_i32 s12, s9, 216
    v_lshl_add_u32 v37, v1, 2, s12
    v_lshl_add_u32 v16, v1, 2, s11
    v_mfma_f32_32x32x16_bf16 v[240:255], a[16:19], v[168:171], v[240:255]
    v_cvt_pk_bf16_f32 v172, v224, v225
    v_cvt_pk_bf16_f32 v174, v236, v237
    v_cvt_pk_bf16_f32 v173, v226, v227
    v_cvt_pk_bf16_f32 v175, v238, v239
    v_permlane16_swap_b32 v172, v174
    s_nop 0
    v_permlane16_swap_b32 v173, v175
    s_nop 1
    v_mfma_f32_32x32x16_bf16 v[52:67], a[8:11], v[172:175], v[52:67]
    buffer_load_dwordx4 a[128:131], v31, s[48:51], s65 offen offset:512 sc1
    s_lshl_b32 s11, s7, 2
    s_add_u32 s11, s11, s3
    s_mul_i32 s25, s11, 71680
    s_add_u32 s25, s25, 19759104
    s_mul_i32 s74, s9, 143360
    s_add_u32 s74, s74, 17465344
    v_mfma_f32_32x32x16_bf16 v[240:255], a[20:23], v[172:175], v[240:255]
    buffer_load_dwordx4 a[132:135], v32, s[48:51], s65 offen offset:768 sc1
    s_add_u32 s65, s65, 15360
    s_mov_b32 s44, s28
    s_mov_b32 s45, s29
    s_mov_b32 s46, 3456
    s_mov_b32 s47, 0x20000
    s_mov_b32 s56, s32
    s_mov_b32 s57, s33
    s_mov_b32 s58, 1280
    s_mov_b32 s59, 0x20000
    s_nop 0
    v_max3_f32 v12, v52, v53, v54
    v_max3_f32 v13, v55, v56, v57
    v_max3_f32 v12, v12, v58, v59
    v_max3_f32 v13, v13, v60, v61
    buffer_load_dwordx4 a[136:139], v31, s[48:51], s65 offen offset:0 sc1
    v_max3_f32 v12, v12, v62, v63
    v_max3_f32 v13, v13, v64, v65
    v_max3_f32 v12, v12, v66, v67
    v_max3_f32 v13, v13, v240, v241
    v_max3_f32 v12, v12, v242, v243
    v_max3_f32 v12, v12, v13, v13
    v_mul_f32 v13, s63, v12
    v_mov_b32 v12, s63
    v_pk_fma_f32 v[68:69], v[52:53], v[12:13], v[12:13] op_sel:[0,0,1] op_sel_hi:[1,0,1] neg_lo:[0,0,1] neg_hi:[0,0,1]
    v_pk_fma_f32 v[70:71], v[54:55], v[12:13], v[12:13] op_sel:[0,0,1] op_sel_hi:[1,0,1] neg_lo:[0,0,1] neg_hi:[0,0,1]
    v_pk_fma_f32 v[72:73], v[56:57], v[12:13], v[12:13] op_sel:[0,0,1] op_sel_hi:[1,0,1] neg_lo:[0,0,1] neg_hi:[0,0,1]
    buffer_load_dwordx4 a[140:143], v31, s[48:51], s65 offen offset:256 sc1
    v_pk_fma_f32 v[74:75], v[58:59], v[12:13], v[12:13] op_sel:[0,0,1] op_sel_hi:[1,0,1] neg_lo:[0,0,1] neg_hi:[0,0,1]
    v_pk_fma_f32 v[76:77], v[60:61], v[12:13], v[12:13] op_sel:[0,0,1] op_sel_hi:[1,0,1] neg_lo:[0,0,1] neg_hi:[0,0,1]
    v_pk_fma_f32 v[78:79], v[62:63], v[12:13], v[12:13] op_sel:[0,0,1] op_sel_hi:[1,0,1] neg_lo:[0,0,1] neg_hi:[0,0,1]
    v_pk_fma_f32 v[80:81], v[64:65], v[12:13], v[12:13] op_sel:[0,0,1] op_sel_hi:[1,0,1] neg_lo:[0,0,1] neg_hi:[0,0,1]
    v_pk_fma_f32 v[82:83], v[66:67], v[12:13], v[12:13] op_sel:[0,0,1] op_sel_hi:[1,0,1] neg_lo:[0,0,1] neg_hi:[0,0,1]
    v_pk_fma_f32 v[84:85], v[240:241], v[12:13], v[12:13] op_sel:[0,0,1] op_sel_hi:[1,0,1] neg_lo:[0,0,1] neg_hi:[0,0,1]
    v_pk_fma_f32 v[86:87], v[242:243], v[12:13], v[12:13] op_sel:[0,0,1] op_sel_hi:[1,0,1] neg_lo:[0,0,1] neg_hi:[0,0,1]
    v_exp_f32 v68, v68
    v_exp_f32 v69, v69
    buffer_load_dwordx4 a[144:147], v31, s[48:51], s65 offen offset:512 sc1
    v_exp_f32 v70, v70
    v_exp_f32 v71, v71
    v_exp_f32 v72, v72
    v_exp_f32 v73, v73
    v_pk_add_f32 v[14:15], v[68:69], v[70:71]
    v_exp_f32 v74, v74
    v_exp_f32 v75, v75
    buffer_load_dwordx4 a[148:151], v32, s[48:51], s65 offen offset:768 sc1
    s_add_u32 s65, s65, 15360
    v_pk_add_f32 v[14:15], v[14:15], v[72:73]
    v_exp_f32 v76, v76
    v_exp_f32 v77, v77
    v_pk_add_f32 v[14:15], v[14:15], v[74:75]
    v_exp_f32 v78, v78
    v_exp_f32 v79, v79
    buffer_load_dwordx4 a[152:155], v31, s[48:51], s65 offen offset:0 sc1
    v_pk_add_f32 v[14:15], v[14:15], v[76:77]
    v_exp_f32 v80, v80
    v_exp_f32 v81, v81
    v_pk_add_f32 v[14:15], v[14:15], v[78:79]
    v_exp_f32 v82, v82
    v_exp_f32 v83, v83
    buffer_load_dwordx4 a[156:159], v31, s[48:51], s65 offen offset:256 sc1
    v_pk_add_f32 v[14:15], v[14:15], v[80:81]
    v_exp_f32 v84, v84
    v_exp_f32 v85, v85
    v_pk_add_f32 v[14:15], v[14:15], v[82:83]
    v_exp_f32 v86, v86
    v_exp_f32 v87, v87
    v_pk_add_f32 v[14:15], v[14:15], v[84:85]
    buffer_load_dwordx4 a[160:163], v31, s[48:51], s65 offen offset:512 sc1
    v_pk_add_f32 v[14:15], v[14:15], v[86:87]
    v_add_f32 v14, v14, v15
    v_rcp_f32_e64 v14, v14
    s_nop 0
    v_pk_mul_f32 v[68:69], v[68:69], v[14:15] op_sel_hi:[1,0]
    v_pk_mul_f32 v[70:71], v[70:71], v[14:15] op_sel_hi:[1,0]
    v_cvt_pk_bf16_f32 v132, v68, v69
    v_pk_mul_f32 v[72:73], v[72:73], v[14:15] op_sel_hi:[1,0]
    v_cvt_pk_bf16_f32 v133, v70, v71
    v_pk_mul_f32 v[74:75], v[74:75], v[14:15] op_sel_hi:[1,0]
    v_cvt_pk_bf16_f32 v136, v72, v73
    buffer_load_dwordx4 a[164:167], v32, s[48:51], s65 offen offset:768 sc1
    v_pk_mul_f32 v[76:77], v[76:77], v[14:15] op_sel_hi:[1,0]
    v_cvt_pk_bf16_f32 v137, v74, v75
    v_pk_mul_f32 v[78:79], v[78:79], v[14:15] op_sel_hi:[1,0]
    v_cvt_pk_bf16_f32 v134, v76, v77
    v_pk_mul_f32 v[80:81], v[80:81], v[14:15] op_sel_hi:[1,0]
    v_cvt_pk_bf16_f32 v135, v78, v79
    v_pk_mul_f32 v[82:83], v[82:83], v[14:15] op_sel_hi:[1,0]
    v_cvt_pk_bf16_f32 v138, v80, v81
    v_pk_mul_f32 v[84:85], v[84:85], v[14:15] op_sel_hi:[1,0]
    v_cvt_pk_bf16_f32 v139, v82, v83
    v_pk_mul_f32 v[86:87], v[86:87], v[14:15] op_sel_hi:[1,0]
    s_cmp_lg_u32 s3, 0
    s_cbranch_scc1 L_pi_60
    s_mov_b32 s68, 8192
    buffer_load_dword v6, v26, s[48:51], s68 offen sc1
L_pi_60:
    v_cvt_pk_bf16_f32 v148, v84, v85
    v_cvt_pk_bf16_f32 v149, v86, v87
    v_min3_f32 v12, v52, v53, v54
    v_min3_f32 v13, v55, v56, v57
    v_min3_f32 v12, v12, v58, v59
    v_min3_f32 v13, v13, v60, v61
    v_min3_f32 v12, v12, v62, v63
    v_min3_f32 v13, v13, v64, v65
    v_min3_f32 v12, v12, v66, v67
    v_min3_f32 v13, v13, v240, v241
    v_min3_f32 v12, v12, v242, v243
    v_min3_f32 v12, v12, v13, v13
    v_mul_f32 v13, s63, v12
    v_mov_b32 v12, s63
    v_pk_fma_f32 v[68:69], v[52:53], v[12:13], v[12:13] op_sel:[0,0,1] op_sel_hi:[1,0,1] neg_lo:[0,1,0] neg_hi:[0,1,0]
    buffer_load_dwordx4 a[168:171], v2, s[48:51], s24 offen offset:0 sc1
    v_pk_fma_f32 v[70:71], v[54:55], v[12:13], v[12:13] op_sel:[0,0,1] op_sel_hi:[1,0,1] neg_lo:[0,1,0] neg_hi:[0,1,0]
    v_pk_fma_f32 v[72:73], v[56:57], v[12:13], v[12:13] op_sel:[0,0,1] op_sel_hi:[1,0,1] neg_lo:[0,1,0] neg_hi:[0,1,0]
    v_pk_fma_f32 v[74:75], v[58:59], v[12:13], v[12:13] op_sel:[0,0,1] op_sel_hi:[1,0,1] neg_lo:[0,1,0] neg_hi:[0,1,0]
    v_pk_fma_f32 v[76:77], v[60:61], v[12:13], v[12:13] op_sel:[0,0,1] op_sel_hi:[1,0,1] neg_lo:[0,1,0] neg_hi:[0,1,0]
    v_pk_fma_f32 v[78:79], v[62:63], v[12:13], v[12:13] op_sel:[0,0,1] op_sel_hi:[1,0,1] neg_lo:[0,1,0] neg_hi:[0,1,0]
    v_pk_fma_f32 v[80:81], v[64:65], v[12:13], v[12:13] op_sel:[0,0,1] op_sel_hi:[1,0,1] neg_lo:[0,1,0] neg_hi:[0,1,0]
    v_pk_fma_f32 v[82:83], v[66:67], v[12:13], v[12:13] op_sel:[0,0,1] op_sel_hi:[1,0,1] neg_lo:[0,1,0] neg_hi:[0,1,0]
    v_pk_fma_f32 v[84:85], v[240:241], v[12:13], v[12:13] op_sel:[0,0,1] op_sel_hi:[1,0,1] neg_lo:[0,1,0] neg_hi:[0,1,0]
    v_pk_fma_f32 v[86:87], v[242:243], v[12:13], v[12:13] op_sel:[0,0,1] op_sel_hi:[1,0,1] neg_lo:[0,1,0] neg_hi:[0,1,0]
    v_exp_f32 v68, v68
    v_exp_f32 v69, v69
    v_exp_f32 v70, v70
    v_exp_f32 v71, v71
    buffer_load_dwordx4 a[172:175], v2, s[48:51], s24 offen offset:1024 sc1
    v_exp_f32 v72, v72
    v_exp_f32 v73, v73
    v_pk_add_f32 v[14:15], v[68:69], v[70:71]
    v_exp_f32 v74, v74
    v_exp_f32 v75, v75
    v_pk_add_f32 v[14:15], v[14:15], v[72:73]
    v_exp_f32 v76, v76
    v_exp_f32 v77, v77
    buffer_load_dwordx4 a[176:179], v2, s[48:51], s24 offen offset:2048 sc1
    v_pk_add_f32 v[14:15], v[14:15], v[74:75]
    v_exp_f32 v78, v78
    v_exp_f32 v79, v79
    v_pk_add_f32 v[14:15], v[14:15], v[76:77]
    v_exp_f32 v80, v80
    v_exp_f32 v81, v81
    v_pk_add_f32 v[14:15], v[14:15], v[78:79]
    v_exp_f32 v82, v82
    v_exp_f32 v83, v83
    buffer_load_dwordx4 a[180:183], v2, s[48:51], s24 offen offset:3072 sc1
    s_add_u32 s24, s24, 4096
    v_pk_add_f32 v[14:15], v[14:15], v[80:81]
    v_exp_f32 v84, v84
    v_exp_f32 v85, v85
    v_pk_add_f32 v[14:15], v[14:15], v[82:83]
    v_exp_f32 v86, v86
    v_exp_f32 v87, v87
    v_pk_add_f32 v[14:15], v[14:15], v[84:85]
    v_pk_add_f32 v[14:15], v[14:15], v[86:87]
    v_add_f32 v14, v14, v15
    v_rcp_f32 v14, v14
    buffer_load_dwordx4 a[192:195], v2, s[48:51], s24 offen offset:0 sc1
    v_pk_mul_f32 v[68:69], v[68:69], v[14:15] op_sel_hi:[1,0]
    v_pk_mul_f32 v[70:71], v[70:71], v[14:15] op_sel_hi:[1,0]
    v_cvt_pk_bf16_f32 v140, v68, v69
    v_pk_mul_f32 v[72:73], v[72:73], v[14:15] op_sel_hi:[1,0]
    v_cvt_pk_bf16_f32 v141, v70, v71
    v_pk_mul_f32 v[74:75], v[74:75], v[14:15] op_sel_hi:[1,0]
    v_cvt_pk_bf16_f32 v144, v72, v73
    v_pk_mul_f32 v[76:77], v[76:77], v[14:15] op_sel_hi:[1,0]
    v_cvt_pk_bf16_f32 v145, v74, v75
    v_pk_mul_f32 v[78:79], v[78:79], v[14:15] op_sel_hi:[1,0]
    v_cvt_pk_bf16_f32 v142, v76, v77
    v_pk_mul_f32 v[80:81], v[80:81], v[14:15] op_sel_hi:[1,0]
    v_cvt_pk_bf16_f32 v143, v78, v79
    v_pk_mul_f32 v[82:83], v[82:83], v[14:15] op_sel_hi:[1,0]
    s_mov_b32 m0, s66
    s_nop 0
    buffer_load_dwordx4 v17, s[40:43], s67 offen offset:0 lds
    v_cvt_pk_bf16_f32 v146, v80, v81
    v_pk_mul_f32 v[84:85], v[84:85], v[14:15] op_sel_hi:[1,0]
    v_cvt_pk_bf16_f32 v147, v82, v83
    v_pk_mul_f32 v[86:87], v[86:87], v[14:15] op_sel_hi:[1,0]
    v_cvt_pk_bf16_f32 v150, v84, v85
    v_cvt_pk_bf16_f32 v151, v86, v87
    s_waitcnt vmcnt(21)
    v_mfma_f32_16x16x32_bf16 v[68:71], a[184:187], a[104:107], 0
    s_mov_b32 m0, s66
    s_nop 0
    buffer_load_dwordx4 v19, s[40:43], s67 offen offset:1024 lds
    s_waitcnt vmcnt(21)
    v_mfma_f32_16x16x32_bf16 v[68:71], a[188:191], a[108:111], v[68:71]
    s_waitcnt vmcnt(20)
    v_mfma_f32_16x16x32_bf16 v[72:75], a[184:187], a[112:115], 0
    s_mov_b32 m0, s66
    s_mov_b32 exec_hi, 0
    buffer_load_dwordx4 v21, s[40:43], s67 offen offset:2048 lds
    s_mov_b64 exec, -1
    s_waitcnt vmcnt(20)
    v_mfma_f32_16x16x32_bf16 v[72:75], a[188:191], a[116:119], v[72:75]
    s_waitcnt vmcnt(19)
    v_mfma_f32_16x16x32_bf16 v[68:71], a[184:187], a[120:123], v[68:71]
    s_add_u32 m0, s66, 3072
    s_nop 0
    buffer_load_dword v37, s[44:47], 0 offen lds
    s_waitcnt vmcnt(19)
    v_mfma_f32_16x16x32_bf16 v[68:71], a[188:191], a[124:127], v[68:71]
    s_waitcnt vmcnt(18)
    v_mfma_f32_16x16x32_bf16 v[72:75], a[184:187], a[128:131], v[72:75]
    s_add_u32 m0, s66, 3328
    s_nop 0
    buffer_load_dword v16, s[56:59], 0 offen lds
    s_waitcnt vmcnt(18)
    v_mfma_f32_16x16x32_bf16 v[72:75], a[188:191], a[132:135], v[72:75]
    s_waitcnt vmcnt(17)
    v_mfma_f32_16x16x32_bf16 v[68:71], a[184:187], a[136:139], v[68:71]
    s_waitcnt vmcnt(16)
    v_mfma_f32_16x16x32_bf16 v[68:71], a[188:191], a[140:143], v[68:71]
    s_waitcnt vmcnt(15)
    v_mfma_f32_16x16x32_bf16 v[72:75], a[184:187], a[144:147], v[72:75]
    s_waitcnt vmcnt(14)
    v_mfma_f32_16x16x32_bf16 v[72:75], a[188:191], a[148:151], v[72:75]
    s_waitcnt vmcnt(13)
    v_mfma_f32_16x16x32_bf16 v[68:71], a[184:187], a[152:155], v[68:71]
    s_waitcnt vmcnt(12)
    v_mfma_f32_16x16x32_bf16 v[68:71], a[188:191], a[156:159], v[68:71]
    s_waitcnt vmcnt(11)
    v_mfma_f32_16x16x32_bf16 v[72:75], a[184:187], a[160:163], v[72:75]
    s_waitcnt vmcnt(10)
    v_mfma_f32_16x16x32_bf16 v[72:75], a[188:191], a[164:167], v[72:75]
    s_nop 3
    v_cvt_pk_bf16_f32 v76, v68, v69
    v_cvt_pk_bf16_f32 v77, v70, v71
    ds_write_b64 v30, v[76:77] offset:0
    s_nop 0
    v_cvt_pk_bf16_f32 v78, v72, v73
    v_cvt_pk_bf16_f32 v79, v74, v75
    ds_write_b64 v30, v[78:79] offset:512
    s_waitcnt lgkmcnt(0)
    s_cmp_lg_u32 s3, 0
    s_cbranch_scc1 L_ok_62
    v_cmp_gt_u32 vcc, 16, v6
    s_cbranch_vccz L_ok_62
    s_mov_b32 s70, 0
L_spin_63:
    buffer_load_dword v6, v26, s[48:51], s68 offen sc1
    s_add_u32 s70, s70, 1
    s_waitcnt vmcnt(0)
    v_cmp_gt_u32 vcc, 16, v6
    s_cmp_lt_u32 s70, 65536
    s_cselect_b64 vcc, vcc, 0
    s_cbranch_vccnz L_spin_63
L_ok_62:
    s_barrier
    ds_read_b128 v[180:183], v28 offset:0
    ds_read_b128 v[188:191], v28 offset:384
    ds_read_b128 v[196:199], v28 offset:768
    ds_read_b128 v[204:207], v28 offset:1152
    ds_read_b128 v[212:215], v28 offset:1536
    ds_read_b128 v[176:179], v27 offset:0
    ds_read_b128 v[184:187], v27 offset:384
    ds_read_b128 v[192:195], v27 offset:768
    ds_read_b128 v[200:203], v27 offset:1152
    ds_read_b128 v[208:211], v27 offset:1536
    s_waitcnt lgkmcnt(8)
    v_mfma_f32_32x32x16_bf16 v[240:255], v[180:183], v[132:135], 0
    buffer_load_dwordx4 a[0:3], v2, s[48:51], s25 offen offset:0 sc1
    v_mfma_f32_32x32x16_bf16 v[240:255], v[188:191], v[136:139], v[240:255]
    s_waitcnt lgkmcnt(0)
    v_mfma_f32_32x32x16_bf16 v[240:255], v[196:199], v[140:143], v[240:255]
    buffer_load_dwordx4 a[4:7], v2, s[48:51], s25 offen offset:1024 sc1
    v_mfma_f32_32x32x16_bf16 v[240:255], v[204:207], v[144:147], v[240:255]
    v_mfma_f32_32x32x16_bf16 v[240:255], v[212:215], v[148:151], v[240:255]
    buffer_load_dwordx4 a[8:11], v2, s[48:51], s25 offen offset:2048 sc1
    v_mfma_f32_32x32x16_bf16 v[52:67], v[176:179], v[132:135], 0
    buffer_load_dwordx4 a[12:15], v2, s[48:51], s25 offen offset:3072 sc1
    s_add_u32 s25, s25, 4096
    v_mfma_f32_32x32x16_bf16 v[52:67], v[184:187], v[136:139], v[52:67]
    buffer_load_dwordx4 a[16:19], v2, s[48:51], s25 offen offset:0 sc1
    v_mfma_f32_32x32x16_bf16 v[52:67], v[192:195], v[140:143], v[52:67]
    s_nop 4
    v_add_f32 v80, 0x358637bd, v244
    v_rcp_f32 v80, v80
    v_mfma_f32_32x32x16_bf16 v[52:67], v[200:203], v[144:147], v[52:67]
    v_mul_f32 v240, v240, v80
    v_mul_f32 v241, v241, v80
    v_mul_f32 v242, v242, v80
    v_mul_f32 v243, v243, v80
    v_cvt_pk_bf16_f32 v76, v240, v241
    v_cvt_pk_bf16_f32 v77, v242, v243
    v_mfma_f32_32x32x16_bf16 v[52:67], v[208:211], v[148:151], v[52:67]
    v_permlane32_swap_b32 v76, v78
    v_permlane32_swap_b32 v77, v79
    s_mov_b32 exec_hi, 0
    buffer_store_dwordx4 v[76:79], v29, s[48:51], s69 offen sc1
    s_mov_b64 exec, -1
    s_nop 6
    v_pk_mul_f32 v[52:53], v[52:53], v[80:81] op_sel_hi:[1,0]
    v_pk_mul_f32 v[54:55], v[54:55], v[80:81] op_sel_hi:[1,0]
    v_pk_mul_f32 v[56:57], v[56:57], v[80:81] op_sel_hi:[1,0]
    v_pk_mul_f32 v[58:59], v[58:59], v[80:81] op_sel_hi:[1,0]
    v_cvt_pk_bf16_f32 v68, v52, v53
    v_cvt_pk_bf16_f32 v69, v54, v55
    v_cvt_pk_bf16_f32 v70, v56, v57
    v_cvt_pk_bf16_f32 v71, v58, v59
    buffer_store_dwordx4 v[68:71], v29, s[48:51], s64 offen offset:0 sc1
    v_pk_mul_f32 v[60:61], v[60:61], v[80:81] op_sel_hi:[1,0]
    v_pk_mul_f32 v[62:63], v[62:63], v[80:81] op_sel_hi:[1,0]
    v_pk_mul_f32 v[64:65], v[64:65], v[80:81] op_sel_hi:[1,0]
    v_pk_mul_f32 v[66:67], v[66:67], v[80:81] op_sel_hi:[1,0]
    v_cvt_pk_bf16_f32 v72, v60, v61
    v_cvt_pk_bf16_f32 v73, v62, v63
    v_cvt_pk_bf16_f32 v74, v64, v65
    v_cvt_pk_bf16_f32 v75, v66, v67
    buffer_store_dwordx4 v[72:75], v29, s[48:51], s64 offen offset:1024 sc1
    v_lshrrev_b32 v9, 4, v1
    v_mul_u32_u24 v10, 40, v9
    v_add_u32_e64 v7, v10, v18
    v_mul_u32_u24 v7, 160, v7
    buffer_load_dwordx4 a[20:23], v2, s[48:51], s25 offen offset:1024 sc1
    buffer_load_dwordx4 a[104:107], v2, s[48:51], s25 offen offset:2048 sc1
    buffer_load_dwordx4 a[108:111], v2, s[48:51], s25 offen offset:3072 sc1
    s_add_u32 s25, s25, 4096
    buffer_load_dwordx4 a[112:115], v2, s[48:51], s25 offen offset:0 sc1
    buffer_load_dwordx4 a[116:119], v2, s[48:51], s25 offen offset:1024 sc1
    buffer_load_dwordx4 a[120:123], v2, s[48:51], s25 offen offset:2048 sc1
    buffer_load_dwordx4 a[124:127], v2, s[48:51], s25 offen offset:3072 sc1
    s_add_u32 s25, s25, 4096
    buffer_load_dwordx4 a[128:131], v2, s[48:51], s25 offen offset:0 sc1
    s_waitcnt vmcnt(8)
    s_waitcnt lgkmcnt(0)
    s_barrier
    s_cmp_lg_u32 s3, 0
    s_cbranch_scc1 L_sig_65
    s_mov_b64 exec, 1
    s_add_u32 s10, s4, 64
    s_lshl_b32 s10, s10, 8
    buffer_atomic_add v4, v5, s[48:51], s10 offen sc1
    s_mov_b64 exec, -1
L_sig_65:
    s_cmp_lg_u32 s3, 1
    s_cbranch_scc1 L_nopf_67
    s_getpc_b64 s[52:53]
L_pc_68:
    s_and_b32 s52, s52, 0xffffff00
    s_mov_b32 s54, L_end-L_pc_68
    s_mov_b32 s55, 0x20000
    s_lshr_b32 s10, s2, 3
    s_lshl_b32 s10, s10, 9
    v_lshlrev_b32 v6, 3, v1
    v_add_u32 v6, s10, v6
    buffer_load_dword v6, v6, s[52:55], 0 offen
L_nopf_67:
    v_add_u32 v10, s66, v10
    v_and_b32 v8, 15, v1
    v_mul_u32_u24 v8, 160, v8
    v_add_u32 v8, v8, v10
    s_add_u32 m0, s0, 0
    s_add_u32 s75, m0, s74
    buffer_load_dwordx4 v2, s[48:51], s75 offen offset:0 sc1 lds
    ds_read_b64 v[200:201], v8 offset:0
    ds_read_b64 v[190:191], v10 offset:3328
    ds_read_b64 v[202:203], v8 offset:8
    ds_read_b64 v[192:193], v10 offset:3336
    ds_read_b64 v[204:205], v8 offset:16
    ds_read_b64 v[194:195], v10 offset:3344
    ds_read_b64 v[206:207], v8 offset:24
    ds_read_b64 v[196:197], v10 offset:3352
    buffer_load_dwordx4 v2, s[48:51], s75 offen offset:1024 sc1 lds
    ds_read_b64 v[208:209], v8 offset:32
    ds_read_b64 v[198:199], v10 offset:3360
    v_lshl_add_u32 v7, v9, 3, s66
    v_min_u32 v9, 2, v9
    v_lshl_add_u32 v9, v9, 3, s66
    ds_read_b64 v[176:177], v7 offset:3072
    ds_read_b64 v[178:179], v7 offset:3104
    ds_read_b64 v[180:181], v7 offset:3136
    ds_read_b64 v[182:183], v7 offset:3168
    ds_read_b64 v[184:185], v7 offset:3200
    ds_read_b64 v[186:187], v7 offset:3232
    ds_read_b64 v[188:189], v9 offset:3264
    buffer_load_dwordx4 v2, s[48:51], s75 offen offset:2048 sc1 lds
    s_mul_i32 s12, s3, 5120
    s_mul_i32 s11, s6, 81920
    s_add_u32 s12, s12, s11
    s_add_u32 s12, s12, 3932160
    s_add_u32 s10, s3, 1
    s_and_b32 s10, s10, 3
    s_mul_i32 s11, s10, 20480
    s_add_u32 s64, s11, s12
    s_mul_i32 s10, s10, 15360
    s_add_u32 s10, s10, 102400
    v_add_u32 v14, s10, v2
    s_add_u32 s10, s3, 2
    s_and_b32 s10, s10, 3
    s_mul_i32 s11, s10, 20480
    s_add_u32 s65, s11, s12
    s_mul_i32 s10, s10, 15360
    s_add_u32 s10, s10, 107520
    v_add_u32 v15, s10, v2
    buffer_load_dwordx4 v2, s[48:51], s75 offen offset:3072 sc1 lds
    s_add_u32 s10, s3, 3
    s_and_b32 s10, s10, 3
    s_mul_i32 s11, s10, 20480
    s_add_u32 s66, s11, s12
    s_mul_i32 s10, s10, 15360
    s_add_u32 s10, s10, 112640
    v_add_u32 v16, s10, v2
    s_add_u32 m0, s0, 4096
    s_add_u32 s75, m0, s74
    buffer_load_dwordx4 v2, s[48:51], s75 offen offset:0 sc1 lds
    s_add_u32 s10, s3, 4
    s_and_b32 s10, s10, 3
    s_mul_i32 s11, s10, 20480
    s_add_u32 s67, s11, s12
    s_mul_i32 s10, s10, 15360
    s_add_u32 s10, s10, 102400
    v_add_u32 v17, s10, v2
    v_add_u32 v11, 61440, v2
    v_add_u32 v12, 122880, v2
    v_mov_b32 v244, s60
    v_mov_b32 v245, s60
    buffer_load_dwordx4 v2, s[48:51], s75 offen offset:1024 sc1 lds
    v_mov_b32 v246, s60
    v_mov_b32 v247, s60
    s_lshl_b32 s71, s6, 2
    s_add_u32 s71, s71, s3
    s_lshl_b32 s73, s71, 3
    s_add_u32 s73, s73, s7
    s_lshl_b32 s73, s73, 7
    s_add_u32 s73, s73, 9175040
    s_mul_i32 s71, s71, 20480
    s_lshr_b32 s10, s7, 1
    s_mul_i32 s10, s10, 5120
    s_add_u32 s71, s71, s10
    s_add_u32 s71, s71, 6553600
    s_and_b32 s10, s7, 1
    s_lshl_b32 s11, s10, 9
    s_add_u32 s72, s71, s11
    s_add_u32 s72, s72, 4096
    s_lshl_b32 s11, s10, 11
    s_add_u32 s71, s71, s11
    s_waitcnt lgkmcnt(15)
    v_lshlrev_b32 v156, 16, v200
    v_and_b32 v157, 0xffff0000, v200
    buffer_load_dwordx4 v2, s[48:51], s75 offen offset:2048 sc1 lds
    v_lshlrev_b32_e64 v158, 16, v201
    v_and_b32 v159, 0xffff0000, v201
    s_waitcnt lgkmcnt(14)
    v_lshlrev_b32 v160, 16, v202
    v_and_b32 v161, 0xffff0000, v202
    v_lshlrev_b32_e64 v162, 16, v203
    v_and_b32 v163, 0xffff0000, v203
    buffer_load_dwordx4 v2, s[48:51], s75 offen offset:3072 sc1 lds
    s_waitcnt lgkmcnt(12)
    v_lshlrev_b32 v164, 16, v204
    v_and_b32 v165, 0xffff0000, v204
    v_lshlrev_b32_e64 v166, 16, v205
    v_and_b32 v167, 0xffff0000, v205
    s_waitcnt lgkmcnt(10)
    v_lshlrev_b32 v168, 16, v206
    v_and_b32 v169, 0xffff0000, v206
    v_lshlrev_b32_e64 v170, 16, v207
    v_and_b32 v171, 0xffff0000, v207
    s_waitcnt lgkmcnt(8)
    v_lshlrev_b32 v172, 16, v208
    v_and_b32 v173, 0xffff0000, v208
    v_lshlrev_b32_e64 v174, 16, v209
    v_and_b32 v175, 0xffff0000, v209
    s_add_u32 m0, s0, 8192
    s_add_u32 s75, m0, s74
    buffer_load_dwordx4 v2, s[48:51], s75 offen offset:0 sc1 lds
    buffer_load_dwordx4 v2, s[48:51], s75 offen offset:1024 sc1 lds
    s_cmp_lg_u32 s3, 0
    s_cbranch_scc1 L_pi_70
    s_add_u32 s68, s1, 64
    s_lshl_b32 s68, s68, 8
    s_mov_b64 exec, 1
    v_mov_b32 v6, 0
    buffer_atomic_add v6, v5, s[48:51], s68 offen sc0 sc1
    s_mov_b64 exec, -1
L_pi_70:
    s_waitcnt lgkmcnt(6)
    v_lshlrev_b32 v128, 16, v176
    v_and_b32 v129, 0xffff0000, v176
    buffer_load_dwordx4 v2, s[48:51], s75 offen offset:2048 sc1 lds
    v_lshlrev_b32_e64 v130, 16, v177
    v_and_b32 v131, 0xffff0000, v177
    s_waitcnt lgkmcnt(5)
    v_lshlrev_b32 v132, 16, v178
    v_and_b32 v133, 0xffff0000, v178
    v_lshlrev_b32_e64 v134, 16, v179
    v_and_b32 v135, 0xffff0000, v179
    s_waitcnt lgkmcnt(4)
    v_lshlrev_b32 v136, 16, v180
    v_and_b32 v137, 0xffff0000, v180
    v_lshlrev_b32_e64 v138, 16, v181
    v_and_b32 v139, 0xffff0000, v181
    buffer_load_dwordx4 v2, s[48:51], s75 offen offset:3072 sc1 lds
    s_waitcnt lgkmcnt(3)
    v_lshlrev_b32 v140, 16, v182
    v_and_b32 v141, 0xffff0000, v182
    v_lshlrev_b32_e64 v142, 16, v183
    v_and_b32 v143, 0xffff0000, v183
    s_waitcnt lgkmcnt(2)
    v_lshlrev_b32 v144, 16, v184
    v_and_b32 v145, 0xffff0000, v184
    v_lshlrev_b32_e64 v146, 16, v185
    v_and_b32 v147, 0xffff0000, v185
    s_waitcnt lgkmcnt(1)
    v_lshlrev_b32 v148, 16, v186
    v_and_b32 v149, 0xffff0000, v186
    v_lshlrev_b32_e64 v150, 16, v187
    v_and_b32 v151, 0xffff0000, v187
    s_add_u32 m0, s0, 12288
    s_add_u32 s75, m0, s74
    buffer_load_dwordx4 v2, s[48:51], s75 offen offset:0 sc1 lds
    s_waitcnt lgkmcnt(0)
    v_lshlrev_b32_e64 v152, 16, v188
    v_and_b32 v153, 0xffff0000, v188
    v_lshlrev_b32_e64 v154, 16, v189
    v_and_b32 v155, 0xffff0000, v189
    buffer_load_dwordx4 v2, s[48:51], s75 offen offset:1024 sc1 lds
    buffer_load_dwordx4 v2, s[48:51], s75 offen offset:2048 sc1 lds
    buffer_load_dwordx4 v2, s[48:51], s75 offen offset:3072 sc1 lds
    s_add_u32 m0, s0, 16384
    s_add_u32 s75, m0, s74
    buffer_load_dwordx4 v2, s[48:51], s75 offen offset:0 sc1 lds
    buffer_load_dwordx4 v2, s[48:51], s75 offen offset:1024 sc1 lds
    s_cmp_lg_u32 s3, 0
    s_cbranch_scc1 L_ok_72
    s_mov_b64 exec, 1
    s_waitcnt vmcnt(8)
    v_cmp_gt_u32 vcc, 16, v6
    s_cbranch_vccz L_pd_75
    s_mov_b32 s70, 0
L_spin_73:
    v_mov_b32 v6, 0
    buffer_atomic_add v6, v5, s[48:51], s68 offen sc0 sc1
    s_add_u32 s70, s70, 1
    s_waitcnt vmcnt(0)
    v_cmp_gt_u32 vcc, 16, v6
    s_cmp_lt_u32 s70, 65536
    s_cselect_b64 vcc, vcc, 0
    s_cbranch_vccnz L_spin_73
L_pd_75:
    s_mov_b64 exec, -1
L_ok_72:
    s_barrier
    buffer_load_dwordx4 v[184:187], v2, s[48:51], s64 offen offset:0 sc1
    s_barrier
    buffer_load_dwordx4 v[180:183], v2, s[48:51], s64 offen offset:1024 sc1
    s_barrier
    buffer_load_dwordx4 v[176:179], v2, s[48:51], s64 offen offset:2048 sc1
    s_barrier
    buffer_load_dwordx4 v[124:127], v2, s[48:51], s64 offen offset:3072 sc1
    s_add_u32 s64, s64, 4096
    s_barrier
    buffer_load_dwordx4 v[120:123], v2, s[48:51], s64 offen offset:0 sc1
    s_barrier
    buffer_load_dwordx4 v[116:119], v2, s[48:51], s65 offen offset:0 sc1
    s_barrier
    buffer_load_dwordx4 v[112:115], v2, s[48:51], s65 offen offset:1024 sc1
    s_barrier
    buffer_load_dwordx4 v[108:111], v2, s[48:51], s65 offen offset:2048 sc1
    s_waitcnt vmcnt(7)
    v_mfma_f32_16x16x32_bf16 v[84:87], a[24:27], v[184:187], 0
    buffer_load_dwordx4 v[104:107], v2, s[48:51], s65 offen offset:3072 sc1
    v_mfma_f32_16x16x32_bf16 v[88:91], a[28:31], v[184:187], 0
    s_add_u32 s65, s65, 4096
    v_mfma_f32_16x16x32_bf16 v[92:95], a[32:35], v[184:187], 0
    v_mfma_f32_16x16x32_bf16 v[96:99], a[36:39], v[184:187], 0
    v_mfma_f32_16x16x32_bf16 v[100:103], a[40:43], v[184:187], 0
    s_waitcnt vmcnt(7)
    v_mfma_f32_16x16x32_bf16 v[84:87], a[44:47], v[180:183], v[84:87]
    buffer_load_dwordx4 v[184:187], v2, s[48:51], s65 offen offset:0 sc1
    v_mfma_f32_16x16x32_bf16 v[88:91], a[48:51], v[180:183], v[88:91]
    v_mfma_f32_16x16x32_bf16 v[92:95], a[52:55], v[180:183], v[92:95]
    v_mfma_f32_16x16x32_bf16 v[96:99], a[56:59], v[180:183], v[96:99]
    v_mfma_f32_16x16x32_bf16 v[100:103], a[60:63], v[180:183], v[100:103]
    s_waitcnt vmcnt(7)
    v_mfma_f32_16x16x32_bf16 v[84:87], a[64:67], v[176:179], v[84:87]
    buffer_load_dwordx4 v[180:183], v2, s[48:51], s66 offen offset:0 sc1
    v_mfma_f32_16x16x32_bf16 v[88:91], a[68:71], v[176:179], v[88:91]
    v_mfma_f32_16x16x32_bf16 v[92:95], a[72:75], v[176:179], v[92:95]
    v_mfma_f32_16x16x32_bf16 v[96:99], a[76:79], v[176:179], v[96:99]
    v_mfma_f32_16x16x32_bf16 v[100:103], a[80:83], v[176:179], v[100:103]
    s_waitcnt vmcnt(7)
    v_mfma_f32_16x16x32_bf16 v[84:87], a[84:87], v[124:127], v[84:87]
    buffer_load_dwordx4 v[176:179], v2, s[48:51], s66 offen offset:1024 sc1
    v_mfma_f32_16x16x32_bf16 v[88:91], a[88:91], v[124:127], v[88:91]
    v_mfma_f32_16x16x32_bf16 v[92:95], a[92:95], v[124:127], v[92:95]
    v_mfma_f32_16x16x32_bf16 v[96:99], a[96:99], v[124:127], v[96:99]
    v_mfma_f32_16x16x32_bf16 v[100:103], a[100:103], v[124:127], v[100:103]
    s_waitcnt vmcnt(7)
    v_mfma_f32_16x16x32_bf16 v[84:87], a[168:171], v[120:123], v[84:87]
    buffer_load_dwordx4 v[124:127], v2, s[48:51], s66 offen offset:2048 sc1
    v_mfma_f32_16x16x32_bf16 v[88:91], a[172:175], v[120:123], v[88:91]
    v_mfma_f32_16x16x32_bf16 v[92:95], a[176:179], v[120:123], v[92:95]
    v_mfma_f32_16x16x32_bf16 v[96:99], a[180:183], v[120:123], v[96:99]
    v_mfma_f32_16x16x32_bf16 v[100:103], a[192:195], v[120:123], v[100:103]
    s_waitcnt vmcnt(7)
    v_mfma_f32_16x16x32_bf16 v[64:67], a[24:27], v[116:119], 0
    buffer_load_dwordx4 v[120:123], v2, s[48:51], s66 offen offset:3072 sc1
    v_mfma_f32_16x16x32_bf16 v[68:71], a[28:31], v[116:119], 0
    s_add_u32 s66, s66, 4096
    v_mfma_f32_16x16x32_bf16 v[72:75], a[32:35], v[116:119], 0
    ds_write_b128 v14, v[84:87] offset:0
    v_mfma_f32_16x16x32_bf16 v[76:79], a[36:39], v[116:119], 0
    v_mfma_f32_16x16x32_bf16 v[80:83], a[40:43], v[116:119], 0
    s_waitcnt vmcnt(7)
    v_mfma_f32_16x16x32_bf16 v[64:67], a[44:47], v[112:115], v[64:67]
    buffer_load_dwordx4 v[116:119], v2, s[48:51], s66 offen offset:0 sc1
    v_mfma_f32_16x16x32_bf16 v[68:71], a[48:51], v[112:115], v[68:71]
    ds_write_b128 v14, v[88:91] offset:1024
    v_mfma_f32_16x16x32_bf16 v[72:75], a[52:55], v[112:115], v[72:75]
    v_mfma_f32_16x16x32_bf16 v[76:79], a[56:59], v[112:115], v[76:79]
    v_mfma_f32_16x16x32_bf16 v[80:83], a[60:63], v[112:115], v[80:83]
    s_waitcnt vmcnt(7)
    v_mfma_f32_16x16x32_bf16 v[64:67], a[64:67], v[108:111], v[64:67]
    buffer_load_dwordx4 v[112:115], v2, s[48:51], s67 offen offset:0 sc1
    v_mfma_f32_16x16x32_bf16 v[68:71], a[68:71], v[108:111], v[68:71]
    ds_write_b128 v14, v[92:95] offset:2048
    v_mfma_f32_16x16x32_bf16 v[72:75], a[72:75], v[108:111], v[72:75]
    v_mfma_f32_16x16x32_bf16 v[76:79], a[76:79], v[108:111], v[76:79]
    v_mfma_f32_16x16x32_bf16 v[80:83], a[80:83], v[108:111], v[80:83]
    s_waitcnt vmcnt(7)
    v_mfma_f32_16x16x32_bf16 v[64:67], a[84:87], v[104:107], v[64:67]
    buffer_load_dwordx4 v[108:111], v2, s[48:51], s67 offen offset:1024 sc1
    v_mfma_f32_16x16x32_bf16 v[68:71], a[88:91], v[104:107], v[68:71]
    ds_write_b128 v14, v[96:99] offset:3072
    v_mfma_f32_16x16x32_bf16 v[72:75], a[92:95], v[104:107], v[72:75]
    v_mfma_f32_16x16x32_bf16 v[76:79], a[96:99], v[104:107], v[76:79]
    v_mfma_f32_16x16x32_bf16 v[80:83], a[100:103], v[104:107], v[80:83]
    s_waitcnt vmcnt(7)
    v_mfma_f32_16x16x32_bf16 v[64:67], a[168:171], v[184:187], v[64:67]
    buffer_load_dwordx4 v[104:107], v2, s[48:51], s67 offen offset:2048 sc1
    v_mfma_f32_16x16x32_bf16 v[68:71], a[172:175], v[184:187], v[68:71]
    ds_write_b128 v14, v[100:103] offset:4096
    v_mfma_f32_16x16x32_bf16 v[72:75], a[176:179], v[184:187], v[72:75]
    v_mfma_f32_16x16x32_bf16 v[76:79], a[180:183], v[184:187], v[76:79]
    v_mfma_f32_16x16x32_bf16 v[80:83], a[192:195], v[184:187], v[80:83]
    s_waitcnt vmcnt(7)
    v_mfma_f32_16x16x32_bf16 v[44:47], a[24:27], v[180:183], 0
    buffer_load_dwordx4 v[184:187], v2, s[48:51], s67 offen offset:3072 sc1
    v_mfma_f32_16x16x32_bf16 v[48:51], a[28:31], v[180:183], 0
    s_add_u32 s67, s67, 4096
    v_mfma_f32_16x16x32_bf16 v[52:55], a[32:35], v[180:183], 0
    ds_write_b128 v15, v[64:67] offset:0
    v_mfma_f32_16x16x32_bf16 v[56:59], a[36:39], v[180:183], 0
    v_mfma_f32_16x16x32_bf16 v[60:63], a[40:43], v[180:183], 0
    s_waitcnt vmcnt(7)
    v_mfma_f32_16x16x32_bf16 v[44:47], a[44:47], v[176:179], v[44:47]
    buffer_load_dwordx4 v[180:183], v2, s[48:51], s67 offen offset:0 sc1
    v_mfma_f32_16x16x32_bf16 v[48:51], a[48:51], v[176:179], v[48:51]
    ds_write_b128 v15, v[68:71] offset:1024
    v_mfma_f32_16x16x32_bf16 v[52:55], a[52:55], v[176:179], v[52:55]
    v_mfma_f32_16x16x32_bf16 v[56:59], a[56:59], v[176:179], v[56:59]
    v_mfma_f32_16x16x32_bf16 v[60:63], a[60:63], v[176:179], v[60:63]
    s_waitcnt vmcnt(7)
    v_mfma_f32_16x16x32_bf16 v[44:47], a[64:67], v[124:127], v[44:47]
    buffer_load_dwordx4 v2, s[48:51], s75 offen offset:2048 sc1 lds
    v_mfma_f32_16x16x32_bf16 v[48:51], a[68:71], v[124:127], v[48:51]
    ds_write_b128 v15, v[72:75] offset:2048
    v_mfma_f32_16x16x32_bf16 v[52:55], a[72:75], v[124:127], v[52:55]
    v_mfma_f32_16x16x32_bf16 v[56:59], a[76:79], v[124:127], v[56:59]
    v_mfma_f32_16x16x32_bf16 v[60:63], a[80:83], v[124:127], v[60:63]
    s_waitcnt vmcnt(7)
    v_mfma_f32_16x16x32_bf16 v[44:47], a[84:87], v[120:123], v[44:47]
    buffer_load_dwordx4 v2, s[48:51], s75 offen offset:3072 sc1 lds
    v_mfma_f32_16x16x32_bf16 v[48:51], a[88:91], v[120:123], v[48:51]
    ds_write_b128 v15, v[76:79] offset:3072
    v_mfma_f32_16x16x32_bf16 v[52:55], a[92:95], v[120:123], v[52:55]
    v_mfma_f32_16x16x32_bf16 v[56:59], a[96:99], v[120:123], v[56:59]
    v_mfma_f32_16x16x32_bf16 v[60:63], a[100:103], v[120:123], v[60:63]
    s_waitcnt vmcnt(7)
    v_mfma_f32_16x16x32_bf16 v[44:47], a[168:171], v[116:119], v[44:47]
    s_add_u32 m0, s0, 20480
    s_add_u32 s75, m0, s74
    buffer_load_dwordx4 v2, s[48:51], s75 offen offset:0 sc1 lds
    v_mfma_f32_16x16x32_bf16 v[48:51], a[172:175], v[116:119], v[48:51]
    ds_write_b128 v15, v[80:83] offset:4096
    v_mfma_f32_16x16x32_bf16 v[52:55], a[176:179], v[116:119], v[52:55]
    v_mfma_f32_16x16x32_bf16 v[56:59], a[180:183], v[116:119], v[56:59]
    v_mfma_f32_16x16x32_bf16 v[60:63], a[192:195], v[116:119], v[60:63]
    s_waitcnt vmcnt(7)
    v_mfma_f32_16x16x32_bf16 v[156:159], a[24:27], v[112:115], v[156:159]
    buffer_load_dwordx4 v2, s[48:51], s75 offen offset:1024 sc1 lds
    v_mfma_f32_16x16x32_bf16 v[160:163], a[28:31], v[112:115], v[160:163]
    ds_write_b128 v16, v[44:47] offset:0
    v_mfma_f32_16x16x32_bf16 v[164:167], a[32:35], v[112:115], v[164:167]
    v_mfma_f32_16x16x32_bf16 v[168:171], a[36:39], v[112:115], v[168:171]
    ds_write_b128 v16, v[48:51] offset:1024
    v_mfma_f32_16x16x32_bf16 v[172:175], a[40:43], v[112:115], v[172:175]
    s_waitcnt vmcnt(7)
    v_mfma_f32_16x16x32_bf16 v[156:159], a[44:47], v[108:111], v[156:159]
    buffer_load_dwordx4 v2, s[48:51], s75 offen offset:2048 sc1 lds
    v_mfma_f32_16x16x32_bf16 v[160:163], a[48:51], v[108:111], v[160:163]
    ds_write_b128 v16, v[52:55] offset:2048
    v_mfma_f32_16x16x32_bf16 v[164:167], a[52:55], v[108:111], v[164:167]
    v_mfma_f32_16x16x32_bf16 v[168:171], a[56:59], v[108:111], v[168:171]
    ds_write_b128 v16, v[56:59] offset:3072
    v_mfma_f32_16x16x32_bf16 v[172:175], a[60:63], v[108:111], v[172:175]
    s_waitcnt vmcnt(7)
    v_mfma_f32_16x16x32_bf16 v[156:159], a[64:67], v[104:107], v[156:159]
    buffer_load_dwordx4 v2, s[48:51], s75 offen offset:3072 sc1 lds
    v_mfma_f32_16x16x32_bf16 v[160:163], a[68:71], v[104:107], v[160:163]
    ds_write_b128 v16, v[60:63] offset:4096
    v_mfma_f32_16x16x32_bf16 v[164:167], a[72:75], v[104:107], v[164:167]
    v_mfma_f32_16x16x32_bf16 v[168:171], a[76:79], v[104:107], v[168:171]
    v_mfma_f32_16x16x32_bf16 v[172:175], a[80:83], v[104:107], v[172:175]
    s_waitcnt vmcnt(7)
    v_mfma_f32_16x16x32_bf16 v[156:159], a[84:87], v[184:187], v[156:159]
    s_waitcnt lgkmcnt(0)
    s_barrier
    v_mfma_f32_16x16x32_bf16 v[160:163], a[88:91], v[184:187], v[160:163]
    s_add_u32 m0, s0, 24576
    s_add_u32 s75, m0, s74
    buffer_load_dwordx4 v2, s[48:51], s75 offen offset:0 sc1 lds
    v_mfma_f32_16x16x32_bf16 v[164:167], a[92:95], v[184:187], v[164:167]
    ds_read_b128 v[84:87], v17 offset:0
    ds_read_b128 v[88:91], v17 offset:1024
    v_mfma_f32_16x16x32_bf16 v[168:171], a[96:99], v[184:187], v[168:171]
    ds_read_b128 v[92:95], v17 offset:2048
    ds_read_b128 v[96:99], v17 offset:3072
    v_mfma_f32_16x16x32_bf16 v[172:175], a[100:103], v[184:187], v[172:175]
    ds_read_b128 v[100:103], v17 offset:4096
    s_waitcnt vmcnt(7)
    v_mfma_f32_16x16x32_bf16 v[156:159], a[168:171], v[180:183], v[156:159]
    ds_read_b128 v[64:67], v17 offset:5120
    ds_read_b128 v[68:71], v17 offset:6144
    v_mfma_f32_16x16x32_bf16 v[160:163], a[172:175], v[180:183], v[160:163]
    buffer_load_dwordx4 a[132:135], v2, s[48:51], s25 offen offset:1024 sc1
    v_mfma_f32_16x16x32_bf16 v[164:167], a[176:179], v[180:183], v[164:167]
    ds_read_b128 v[72:75], v17 offset:7168
    ds_read_b128 v[76:79], v17 offset:8192
    v_mfma_f32_16x16x32_bf16 v[168:171], a[180:183], v[180:183], v[168:171]
    ds_read_b128 v[80:83], v17 offset:9216
    ds_read_b128 v[44:47], v17 offset:10240
    v_mfma_f32_16x16x32_bf16 v[172:175], a[192:195], v[180:183], v[172:175]
    ds_read_b128 v[48:51], v17 offset:11264
    ds_read_b128 v[52:55], v17 offset:12288
    ds_read_b128 v[56:59], v17 offset:13312
    ds_read_b128 v[60:63], v17 offset:14336
    s_waitcnt lgkmcnt(8)
    v_pk_add_f32 v[84:85], v[84:85], v[64:65]
    v_pk_add_f32 v[86:87], v[86:87], v[66:67]
    v_pk_add_f32 v[88:89], v[88:89], v[68:69]
    v_pk_add_f32 v[90:91], v[90:91], v[70:71]
    s_waitcnt lgkmcnt(6)
    v_pk_add_f32 v[92:93], v[92:93], v[72:73]
    v_pk_add_f32 v[94:95], v[94:95], v[74:75]
    v_pk_add_f32 v[96:97], v[96:97], v[76:77]
    v_pk_add_f32 v[98:99], v[98:99], v[78:79]
    s_waitcnt lgkmcnt(5)
    v_pk_add_f32 v[100:101], v[100:101], v[80:81]
    v_pk_add_f32 v[102:103], v[102:103], v[82:83]
    s_waitcnt lgkmcnt(3)
    v_pk_add_f32 v[84:85], v[84:85], v[44:45]
    v_pk_add_f32 v[86:87], v[86:87], v[46:47]
    v_pk_add_f32 v[88:89], v[88:89], v[48:49]
    v_pk_add_f32 v[90:91], v[90:91], v[50:51]
    s_waitcnt lgkmcnt(1)
    v_pk_add_f32 v[92:93], v[92:93], v[52:53]
    v_pk_add_f32 v[94:95], v[94:95], v[54:55]
    v_pk_add_f32 v[96:97], v[96:97], v[56:57]
    v_pk_add_f32 v[98:99], v[98:99], v[58:59]
    s_waitcnt lgkmcnt(0)
    s_nop 0
    v_pk_add_f32 v[100:101], v[100:101], v[60:61]
    v_pk_add_f32 v[102:103], v[102:103], v[62:63]
    v_pk_add_f32 v[172:173], v[172:173], v[100:101]
    v_pk_add_f32 v[174:175], v[174:175], v[102:103]
    v_cvt_pk_bf16_f32 v208, v172, v173
    v_cvt_pk_bf16_f32 v209, v174, v175
    v_mov_b32 v7, v208
    v_mov_b32 v8, v209
    v_mov_b32 v14, 0
    v_mov_b32 v15, 0
    v_permlane32_swap_b32 v7, v210
    v_permlane32_swap_b32 v8, v211
    s_mov_b32 exec_hi, 0
    buffer_store_dwordx4 v[208:211], v2, s[48:51], s72 offen sc1
    s_mov_b64 exec, -1
    v_pk_add_f32 v[156:157], v[156:157], v[84:85]
    v_pk_add_f32 v[158:159], v[158:159], v[86:87]
    v_pk_add_f32 v[160:161], v[160:161], v[88:89]
    v_pk_add_f32 v[162:163], v[162:163], v[90:91]
    v_cvt_pk_bf16_f32 v200, v156, v157
    v_cvt_pk_bf16_f32 v201, v158, v159
    v_cvt_pk_bf16_f32 v202, v160, v161
    v_cvt_pk_bf16_f32 v203, v162, v163
    buffer_store_dwordx4 v[200:203], v2, s[48:51], s71 offen offset:0 sc1
    v_pk_add_f32 v[164:165], v[164:165], v[92:93]
    v_pk_add_f32 v[166:167], v[166:167], v[94:95]
    v_pk_add_f32 v[168:169], v[168:169], v[96:97]
    v_pk_add_f32 v[170:171], v[170:171], v[98:99]
    v_cvt_pk_bf16_f32 v204, v164, v165
    v_cvt_pk_bf16_f32 v205, v166, v167
    v_cvt_pk_bf16_f32 v206, v168, v169
    v_cvt_pk_bf16_f32 v207, v170, v171
    buffer_store_dwordx4 v[204:207], v2, s[48:51], s71 offen offset:1024 sc1
    v_dot2c_f32_bf16 v14, s60, v200
    v_dot2c_f32_bf16 v15, v200, v200
    v_dot2c_f32_bf16 v14, s60, v201
    v_dot2c_f32_bf16 v15, v201, v201
    v_dot2c_f32_bf16 v14, s60, v202
    v_dot2c_f32_bf16 v15, v202, v202
    v_dot2c_f32_bf16 v14, s60, v203
    v_dot2c_f32_bf16 v15, v203, v203
    v_dot2c_f32_bf16 v14, s60, v204
    v_dot2c_f32_bf16 v15, v204, v204
    v_dot2c_f32_bf16 v14, s60, v205
    v_dot2c_f32_bf16 v15, v205, v205
    v_dot2c_f32_bf16 v14, s60, v206
    v_dot2c_f32_bf16 v15, v206, v206
    v_dot2c_f32_bf16 v14, s60, v207
    v_dot2c_f32_bf16 v15, v207, v207
    v_dot2c_f32_bf16 v14, s60, v208
    v_dot2c_f32_bf16 v15, v208, v208
    v_dot2c_f32_bf16 v14, s60, v209
    v_dot2c_f32_bf16 v15, v209, v209
    s_nop 1
    v_mov_b32 v7, v14
    v_mov_b32 v8, v15
    s_nop 0
    v_permlane16_swap_b32 v7, v14
    v_permlane16_swap_b32 v8, v15
    v_add_f32 v14, v14, v7
    v_add_f32 v15, v15, v8
    v_mov_b32 v7, v14
    v_mov_b32 v8, v15
    s_nop 0
    v_permlane32_swap_b32 v7, v14
    v_permlane32_swap_b32 v8, v15
    v_add_f32 v14, v14, v7
    v_add_f32 v15, v15, v8
    s_mov_b64 exec, 0xffff
    buffer_store_dwordx2 v[14:15], v3, s[48:51], s73 offen sc1
    s_mov_b64 exec, -1
    s_mul_i32 s0, s3, 10240
    s_barrier
    v_lshlrev_b32 v18, 16, v190
    v_and_b32 v19, 0xffff0000, v190
    s_add_u32 m0, s0, 102400
    s_add_u32 s75, m0, s74
    buffer_load_dwordx4 v2, s[48:51], s75 offen offset:0 sc1 lds
    v_lshlrev_b32 v156, 16, v200
    v_and_b32 v157, 0xffff0000, v200
    v_pk_add_f32 v[156:157], v[156:157], v[18:19]
    v_lshlrev_b32_e64 v18, 16, v191
    v_and_b32 v19, 0xffff0000, v191
    v_lshlrev_b32_e64 v158, 16, v201
    v_and_b32 v159, 0xffff0000, v201
    v_pk_add_f32 v[158:159], v[158:159], v[18:19]
    v_lshlrev_b32_e64 v18, 16, v192
    v_and_b32 v19, 0xffff0000, v192
    buffer_load_dwordx4 v2, s[48:51], s75 offen offset:1024 sc1 lds
    v_lshlrev_b32_e64 v160, 16, v202
    v_and_b32 v161, 0xffff0000, v202
    v_pk_add_f32 v[160:161], v[160:161], v[18:19]
    v_lshlrev_b32_e64 v18, 16, v193
    v_and_b32 v19, 0xffff0000, v193
    v_lshlrev_b32_e64 v162, 16, v203
    v_and_b32 v163, 0xffff0000, v203
    v_pk_add_f32 v[162:163], v[162:163], v[18:19]
    v_lshlrev_b32_e64 v18, 16, v194
    v_and_b32 v19, 0xffff0000, v194
    v_lshlrev_b32_e64 v164, 16, v204
    v_and_b32 v165, 0xffff0000, v204
    buffer_load_dwordx4 v2, s[48:51], s75 offen offset:2048 sc1 lds
    v_pk_add_f32 v[164:165], v[164:165], v[18:19]
    v_lshlrev_b32_e64 v18, 16, v195
    v_and_b32 v19, 0xffff0000, v195
    v_lshlrev_b32_e64 v166, 16, v205
    v_and_b32 v167, 0xffff0000, v205
    v_pk_add_f32 v[166:167], v[166:167], v[18:19]
    v_lshlrev_b32_e64 v18, 16, v196
    v_and_b32 v19, 0xffff0000, v196
    v_lshlrev_b32_e64 v168, 16, v206
    v_and_b32 v169, 0xffff0000, v206
    v_pk_add_f32 v[168:169], v[168:169], v[18:19]
    v_lshlrev_b32_e64 v18, 16, v197
    v_and_b32 v19, 0xffff0000, v197
    buffer_load_dwordx4 v2, s[48:51], s75 offen offset:3072 sc1 lds
    v_lshlrev_b32_e64 v170, 16, v207
    v_and_b32 v171, 0xffff0000, v207
    v_pk_add_f32 v[170:171], v[170:171], v[18:19]
    v_lshlrev_b32_e64 v18, 16, v198
    v_and_b32 v19, 0xffff0000, v198
    v_lshlrev_b32_e64 v172, 16, v208
    v_and_b32 v173, 0xffff0000, v208
    v_pk_add_f32 v[172:173], v[172:173], v[18:19]
    v_lshlrev_b32_e64 v18, 16, v199
    v_and_b32 v19, 0xffff0000, v199
    v_lshlrev_b32_e64 v174, 16, v209
    v_and_b32 v175, 0xffff0000, v209
    s_add_u32 m0, s0, 106496
    s_add_u32 s75, m0, s74
    buffer_load_dwordx4 v2, s[48:51], s75 offen offset:0 sc1 lds
    v_pk_add_f32 v[174:175], v[174:175], v[18:19]
    v_lshrrev_b32 v7, 4, v1
    v_and_b32 v8, 15, v1
    v_lshlrev_b32 v8, 3, v8
    v_lshl_add_u32 v14, v7, 8, v8
    s_lshl_b32 s10, s3, 6
    v_lshlrev_b32 v7, 4, v7
    v_add_u32 v16, 143360, v7
    v_add_u32 v15, s10, v16
    s_mul_i32 s10, s3, 20480
    v_add_u32 v13, s10, v2
    buffer_load_dwordx4 v2, s[48:51], s75 offen offset:1024 sc1 lds
    s_lshl_b32 s10, s8, 3
    s_lshl_b32 s11, s3, 1
    s_add_u32 s10, s10, s11
    s_mul_i32 s64, s10, 20480
    s_add_u32 s64, s64, 6553600
    s_add_u32 s65, s64, 20480
    s_lshl_b32 s66, s10, 10
    s_add_u32 s66, s66, 9175040
    s_mul_i32 s67, s10, 57344
    s_lshr_b32 s11, s9, 1
    s_mul_i32 s11, s11, 7168
    s_add_u32 s67, s67, s11
    s_add_u32 s67, s67, 9306112
    s_and_b32 s10, s9, 1
    s_lshl_b32 s11, s10, 9
    s_add_u32 s69, s67, s11
    s_add_u32 s69, s69, 6144
    s_mul_i32 s11, s10, 3072
    s_add_u32 s67, s67, s11
    buffer_load_dwordx4 v2, s[48:51], s75 offen offset:2048 sc1 lds
    buffer_load_dwordx4 v2, s[48:51], s75 offen offset:3072 sc1 lds
    s_waitcnt vmcnt(8)
    s_barrier
    s_cmp_lg_u32 s3, 0
    s_cbranch_scc1 L_sig_76
    s_mov_b64 exec, 1
    s_add_u32 s10, s1, 80
    s_lshl_b32 s10, s10, 8
    buffer_atomic_add v4, v5, s[48:51], s10 offen sc1
    s_mov_b64 exec, -1
L_sig_76:
    s_cmp_lg_u32 s3, 1
    s_cbranch_scc1 L_nopf_78
    s_getpc_b64 s[52:53]
L_pc_79:
    s_and_b32 s52, s52, 0xffffff00
    s_mov_b32 s54, L_end-L_pc_79
    s_mov_b32 s55, 0x20000
    s_lshr_b32 s10, s2, 3
    s_lshl_b32 s10, s10, 9
    v_lshlrev_b32 v6, 3, v1
    v_add_u32 v6, s10, v6
    buffer_load_dword v6, v6, s[52:55], 0 offen
L_nopf_78:
    ds_read_b128 v[240:243], v13 offset:0
    s_add_u32 m0, s0, 110592
    s_add_u32 s75, m0, s74
    buffer_load_dwordx4 v2, s[48:51], s75 offen offset:0 sc1 lds
    ds_read_b128 v[236:239], v13 offset:1024
    ds_read_b128 v[232:235], v13 offset:2048
    ds_read_b128 v[228:231], v13 offset:3072
    ds_read_b128 v[224:227], v13 offset:4096
    ds_read_b128 v[220:223], v13 offset:5120
    s_waitcnt lgkmcnt(5)
    v_mfma_f32_16x16x32_bf16 v[248:251], v[240:243], v[244:247], 0
    ds_read_b128 v[216:219], v13 offset:6144
    s_waitcnt lgkmcnt(5)
    v_mfma_f32_16x16x32_bf16 v[248:251], v[236:239], v[244:247], v[248:251]
    ds_read_b128 v[212:215], v13 offset:7168
    buffer_load_dwordx4 v2, s[48:51], s75 offen offset:1024 sc1 lds
    s_waitcnt lgkmcnt(5)
    v_mfma_f32_16x16x32_bf16 v[248:251], v[232:235], v[244:247], v[248:251]
    ds_read_b128 v[240:243], v13 offset:8192
    s_waitcnt lgkmcnt(5)
    v_mfma_f32_16x16x32_bf16 v[248:251], v[228:231], v[244:247], v[248:251]
    ds_read_b128 v[236:239], v13 offset:9216
    s_waitcnt lgkmcnt(5)
    v_mfma_f32_16x16x32_bf16 v[248:251], v[224:227], v[244:247], v[248:251]
    ds_read_b128 v[232:235], v13 offset:10240
    s_waitcnt lgkmcnt(5)
    v_mfma_f32_16x16x32_bf16 v[248:251], v[220:223], v[244:247], v[248:251]
    buffer_load_dwordx4 a[24:27], v2, s[48:51], s25 offen offset:2048 sc1
    ds_read_b128 v[228:231], v13 offset:11264
    s_waitcnt lgkmcnt(5)
    v_mfma_f32_16x16x32_bf16 v[248:251], v[216:219], v[244:247], v[248:251]
    ds_read_b128 v[224:227], v13 offset:12288
    s_waitcnt lgkmcnt(5)
    v_mfma_f32_16x16x32_bf16 v[248:251], v[212:215], v[244:247], v[248:251]
    ds_read_b128 v[220:223], v13 offset:13312
    s_waitcnt lgkmcnt(5)
    v_mfma_f32_16x16x32_bf16 v[248:251], v[240:243], v[244:247], v[248:251]
    buffer_load_dwordx4 a[28:31], v2, s[48:51], s25 offen offset:3072 sc1
    s_add_u32 s25, s25, 4096
    ds_read_b128 v[216:219], v13 offset:14336
    s_waitcnt lgkmcnt(5)
    v_mfma_f32_16x16x32_bf16 v[248:251], v[236:239], v[244:247], v[248:251]
    ds_read_b128 v[212:215], v13 offset:15360
    s_waitcnt lgkmcnt(5)
    v_mfma_f32_16x16x32_bf16 v[248:251], v[232:235], v[244:247], v[248:251]
    ds_read_b128 v[240:243], v13 offset:16384
    s_waitcnt lgkmcnt(5)
    v_mfma_f32_16x16x32_bf16 v[248:251], v[228:231], v[244:247], v[248:251]
    buffer_load_dwordx4 a[32:35], v2, s[48:51], s25 offen offset:0 sc1
    ds_read_b128 v[236:239], v13 offset:17408
    s_waitcnt lgkmcnt(5)
    v_mfma_f32_16x16x32_bf16 v[248:251], v[224:227], v[244:247], v[248:251]
    ds_read_b128 v[232:235], v13 offset:18432
    s_waitcnt lgkmcnt(5)
    v_mfma_f32_16x16x32_bf16 v[248:251], v[220:223], v[244:247], v[248:251]
    ds_read_b128 v[228:231], v13 offset:19456
    s_waitcnt lgkmcnt(5)
    v_mfma_f32_16x16x32_bf16 v[248:251], v[216:219], v[244:247], v[248:251]
    buffer_load_dwordx4 a[36:39], v2, s[48:51], s25 offen offset:1024 sc1
    s_waitcnt lgkmcnt(4)
    v_mfma_f32_16x16x32_bf16 v[248:251], v[212:215], v[244:247], v[248:251]
    s_waitcnt lgkmcnt(3)
    v_mfma_f32_16x16x32_bf16 v[248:251], v[240:243], v[244:247], v[248:251]
    s_waitcnt lgkmcnt(2)
    v_mfma_f32_16x16x32_bf16 v[248:251], v[236:239], v[244:247], v[248:251]
    s_waitcnt lgkmcnt(1)
    v_mfma_f32_16x16x32_bf16 v[248:251], v[232:235], v[244:247], v[248:251]
    buffer_load_dwordx4 a[40:43], v2, s[48:51], s25 offen offset:2048 sc1
    s_waitcnt lgkmcnt(0)
    v_mfma_f32_16x16x32_bf16 v[248:251], v[228:231], v[244:247], v[248:251]
    buffer_load_dwordx4 a[44:47], v2, s[48:51], s25 offen offset:3072 sc1
    s_add_u32 s25, s25, 4096
    buffer_load_dwordx4 a[48:51], v2, s[48:51], s25 offen offset:0 sc1
    s_cmp_lg_u32 s3, 0
    s_cbranch_scc1 L_pi_81
    s_add_u32 s68, s8, 80
    s_lshl_b32 s68, s68, 8
    s_mov_b64 exec, 1
    v_mov_b32 v6, 0
    buffer_atomic_add v6, v5, s[48:51], s68 offen sc0 sc1
    s_mov_b64 exec, -1
L_pi_81:
    s_min_u32 s10, s3, 2
    s_mul_i32 s10, s10, 20480
    s_add_u32 s10, s10, 81920
    v_add_u32 v13, s10, v2
    buffer_load_dwordx4 a[52:55], v2, s[48:51], s25 offen offset:1024 sc1
    buffer_load_dwordx4 a[56:59], v2, s[48:51], s25 offen offset:2048 sc1
    s_waitcnt vmcnt(9)
    s_barrier
    ds_read_b128 v[240:243], v13 offset:0
    buffer_load_dwordx4 a[60:63], v2, s[48:51], s25 offen offset:3072 sc1
    s_add_u32 s25, s25, 4096
    ds_read_b128 v[236:239], v13 offset:1024
    ds_read_b128 v[232:235], v13 offset:2048
    ds_read_b128 v[228:231], v13 offset:3072
    ds_read_b128 v[224:227], v13 offset:4096
    ds_read_b128 v[220:223], v13 offset:5120
    s_waitcnt lgkmcnt(5)
    v_mfma_f32_16x16x32_bf16 v[252:255], v[240:243], v[244:247], 0
    ds_read_b128 v[216:219], v13 offset:6144
    s_waitcnt lgkmcnt(5)
    v_mfma_f32_16x16x32_bf16 v[252:255], v[236:239], v[244:247], v[252:255]
    ds_read_b128 v[212:215], v13 offset:7168
    buffer_load_dwordx4 a[64:67], v2, s[48:51], s25 offen offset:0 sc1
    s_waitcnt lgkmcnt(5)
    v_mfma_f32_16x16x32_bf16 v[252:255], v[232:235], v[244:247], v[252:255]
    ds_read_b128 v[240:243], v13 offset:8192
    s_waitcnt lgkmcnt(5)
    v_mfma_f32_16x16x32_bf16 v[252:255], v[228:231], v[244:247], v[252:255]
    ds_read_b128 v[236:239], v13 offset:9216
    s_waitcnt lgkmcnt(5)
    v_mfma_f32_16x16x32_bf16 v[252:255], v[224:227], v[244:247], v[252:255]
    ds_read_b128 v[232:235], v13 offset:10240
    s_waitcnt lgkmcnt(5)
    v_mfma_f32_16x16x32_bf16 v[252:255], v[220:223], v[244:247], v[252:255]
    buffer_load_dwordx4 a[68:71], v2, s[48:51], s25 offen offset:1024 sc1
    ds_read_b128 v[228:231], v13 offset:11264
    s_waitcnt lgkmcnt(5)
    v_mfma_f32_16x16x32_bf16 v[252:255], v[216:219], v[244:247], v[252:255]
    ds_read_b128 v[224:227], v13 offset:12288
    s_waitcnt lgkmcnt(5)
    v_mfma_f32_16x16x32_bf16 v[252:255], v[212:215], v[244:247], v[252:255]
    ds_read_b128 v[220:223], v13 offset:13312
    s_waitcnt lgkmcnt(5)
    v_mfma_f32_16x16x32_bf16 v[252:255], v[240:243], v[244:247], v[252:255]
    buffer_load_dwordx4 a[72:75], v2, s[48:51], s25 offen offset:2048 sc1
    ds_read_b128 v[216:219], v13 offset:14336
    s_waitcnt lgkmcnt(5)
    v_mfma_f32_16x16x32_bf16 v[252:255], v[236:239], v[244:247], v[252:255]
    ds_read_b128 v[212:215], v13 offset:15360
    s_waitcnt lgkmcnt(5)
    v_mfma_f32_16x16x32_bf16 v[252:255], v[232:235], v[244:247], v[252:255]
    ds_read_b128 v[240:243], v13 offset:16384
    s_waitcnt lgkmcnt(5)
    v_mfma_f32_16x16x32_bf16 v[252:255], v[228:231], v[244:247], v[252:255]
    buffer_load_dwordx4 a[76:79], v2, s[48:51], s25 offen offset:3072 sc1
    s_add_u32 s25, s25, 4096
    ds_read_b128 v[236:239], v13 offset:17408
    s_waitcnt lgkmcnt(5)
    v_mfma_f32_16x16x32_bf16 v[252:255], v[224:227], v[244:247], v[252:255]
    ds_read_b128 v[232:235], v13 offset:18432
    s_waitcnt lgkmcnt(5)
    v_mfma_f32_16x16x32_bf16 v[252:255], v[220:223], v[244:247], v[252:255]
    ds_read_b128 v[228:231], v13 offset:19456
    s_waitcnt lgkmcnt(5)
    v_mfma_f32_16x16x32_bf16 v[252:255], v[216:219], v[244:247], v[252:255]
    buffer_load_dwordx4 a[80:83], v2, s[48:51], s25 offen offset:0 sc1
    s_waitcnt lgkmcnt(4)
    v_mfma_f32_16x16x32_bf16 v[252:255], v[212:215], v[244:247], v[252:255]
    s_waitcnt lgkmcnt(3)
    v_mfma_f32_16x16x32_bf16 v[252:255], v[240:243], v[244:247], v[252:255]
    s_waitcnt lgkmcnt(2)
    v_mfma_f32_16x16x32_bf16 v[252:255], v[236:239], v[244:247], v[252:255]
    s_waitcnt lgkmcnt(1)
    v_mfma_f32_16x16x32_bf16 v[252:255], v[232:235], v[244:247], v[252:255]
    s_waitcnt lgkmcnt(0)
    v_mfma_f32_16x16x32_bf16 v[252:255], v[228:231], v[244:247], v[252:255]
    s_mov_b32 exec_lo, 0x00010001
    s_mov_b32 exec_hi, 0x00010001
    ds_write_b128 v15, v[248:251]
    s_nop 4
    ds_write_b128 v15, v[252:255] offset:256
    s_mov_b64 exec, -1
    s_waitcnt lgkmcnt(0)
    s_cmp_lg_u32 s3, 0
    s_cbranch_scc1 L_ok_83
    s_mov_b64 exec, 1
    s_waitcnt vmcnt(8)
    v_cmp_gt_u32 vcc, 16, v6
    s_cbranch_vccz L_pd_86
    s_mov_b32 s70, 0
L_spin_84:
    v_mov_b32 v6, 0
    buffer_atomic_add v6, v5, s[48:51], s68 offen sc0 sc1
    s_add_u32 s70, s70, 1
    s_waitcnt vmcnt(0)
    v_cmp_gt_u32 vcc, 16, v6
    s_cmp_lt_u32 s70, 65536
    s_cselect_b64 vcc, vcc, 0
    s_cbranch_vccnz L_spin_84
L_pd_86:
    s_mov_b64 exec, -1
L_ok_83:
    s_barrier
    buffer_load_dwordx4 a[84:87], v2, s[48:51], s64 offen offset:0 sc1
    buffer_load_dwordx4 a[88:91], v2, s[48:51], s65 offen offset:0 sc1
    s_barrier
    buffer_load_dwordx4 a[92:95], v2, s[48:51], s64 offen offset:1024 sc1
    buffer_load_dwordx4 a[96:99], v2, s[48:51], s65 offen offset:1024 sc1
    buffer_load_dwordx4 a[100:103], v2, s[48:51], s64 offen offset:2048 sc1
    buffer_load_dwordx4 a[136:139], v2, s[48:51], s65 offen offset:2048 sc1
    buffer_load_dwordx4 a[140:143], v2, s[48:51], s64 offen offset:3072 sc1
    buffer_load_dwordx4 a[144:147], v2, s[48:51], s65 offen offset:3072 sc1
    s_add_u32 s64, s64, 4096
    s_add_u32 s65, s65, 4096
    ds_read_b128 v[184:187], v16 offset:0
    ds_read_b128 v[188:191], v16 offset:64
    ds_read_b128 v[192:195], v16 offset:128
    ds_read_b128 v[196:199], v16 offset:192
    ds_read_b128 v[200:203], v16 offset:256
    ds_read_b128 v[204:207], v16 offset:320
    ds_read_b128 v[208:211], v16 offset:384
    ds_read_b128 v[240:243], v2 offset:0
    ds_read_b128 v[236:239], v2 offset:20480
    ds_read_b128 v[232:235], v2 offset:40960
    ds_read_b128 v[228:231], v11 offset:0
    ds_read_b128 v[224:227], v11 offset:20480
    ds_read_b128 v[220:223], v11 offset:40960
    s_waitcnt lgkmcnt(4) vmcnt(6)
    v_mfma_f32_16x16x32_bf16 v[72:75], v[240:243], a[84:87], 0
    buffer_load_dwordx4 a[148:151], v2, s[48:51], s64 offen offset:0 sc1
    v_mfma_f32_16x16x32_bf16 v[100:103], v[240:243], a[88:91], 0
    ds_read_b128 v[216:219], v12 offset:0
    v_mfma_f32_16x16x32_bf16 v[76:79], v[236:239], a[84:87], 0
    buffer_load_dwordx2 v[248:249], v14, s[48:51], s66 offen offset:0 sc1
    v_mfma_f32_16x16x32_bf16 v[104:107], v[236:239], a[88:91], 0
    ds_read_b128 v[212:215], v2 offset:1024
    s_waitcnt lgkmcnt(4)
    v_mfma_f32_16x16x32_bf16 v[80:83], v[232:235], a[84:87], 0
    buffer_load_dwordx4 a[152:155], v2, s[48:51], s65 offen offset:0 sc1
    v_mfma_f32_16x16x32_bf16 v[108:111], v[232:235], a[88:91], 0
    ds_read_b128 v[240:243], v2 offset:21504
    v_mfma_f32_16x16x32_bf16 v[84:87], v[228:231], a[84:87], 0
    buffer_load_dwordx2 v[250:251], v14, s[48:51], s66 offen offset:128 sc1
    v_mfma_f32_16x16x32_bf16 v[112:115], v[228:231], a[88:91], 0
    ds_read_b128 v[236:239], v2 offset:41984
    s_waitcnt lgkmcnt(4)
    v_mfma_f32_16x16x32_bf16 v[88:91], v[224:227], a[84:87], 0
    buffer_load_dwordx4 a[156:159], v2, s[48:51], s64 offen offset:1024 sc1
    v_mfma_f32_16x16x32_bf16 v[116:119], v[224:227], a[88:91], 0
    ds_read_b128 v[232:235], v11 offset:1024
    v_mfma_f32_16x16x32_bf16 v[92:95], v[220:223], a[84:87], 0
    buffer_load_dwordx2 v[252:253], v14, s[48:51], s66 offen offset:1024 sc1
    v_mfma_f32_16x16x32_bf16 v[120:123], v[220:223], a[88:91], 0
    ds_read_b128 v[228:231], v11 offset:21504
    s_waitcnt lgkmcnt(4)
    v_mfma_f32_16x16x32_bf16 v[96:99], v[216:219], a[84:87], 0
    buffer_load_dwordx4 a[84:87], v2, s[48:51], s65 offen offset:1024 sc1
    v_mfma_f32_16x16x32_bf16 v[124:127], v[216:219], a[88:91], 0
    ds_read_b128 v[224:227], v11 offset:41984
    s_waitcnt vmcnt(11)
    v_mfma_f32_16x16x32_bf16 v[72:75], v[212:215], a[92:95], v[72:75]
    buffer_load_dwordx2 v[254:255], v14, s[48:51], s66 offen offset:1152 sc1
    v_mfma_f32_16x16x32_bf16 v[100:103], v[212:215], a[96:99], v[100:103]
    ds_read_b128 v[220:223], v12 offset:1024
    s_waitcnt lgkmcnt(4)
    v_mfma_f32_16x16x32_bf16 v[76:79], v[240:243], a[92:95], v[76:79]
    buffer_load_dwordx4 a[88:91], v2, s[48:51], s64 offen offset:2048 sc1
    v_mfma_f32_16x16x32_bf16 v[104:107], v[240:243], a[96:99], v[104:107]
    ds_read_b128 v[216:219], v2 offset:2048
    s_add_u32 s71, s67, 57344
    v_mfma_f32_16x16x32_bf16 v[80:83], v[236:239], a[92:95], v[80:83]
    s_add_u32 s72, s69, 57344
    v_mfma_f32_16x16x32_bf16 v[108:111], v[236:239], a[96:99], v[108:111]
    ds_read_b128 v[212:215], v2 offset:22528
    s_waitcnt lgkmcnt(4)
    v_mfma_f32_16x16x32_bf16 v[84:87], v[232:235], a[92:95], v[84:87]
    buffer_load_dwordx4 a[160:163], v2, s[48:51], s65 offen offset:2048 sc1
    v_mfma_f32_16x16x32_bf16 v[112:115], v[232:235], a[96:99], v[112:115]
    ds_read_b128 v[240:243], v2 offset:43008
    v_mfma_f32_16x16x32_bf16 v[88:91], v[228:231], a[92:95], v[88:91]
    v_mfma_f32_16x16x32_bf16 v[116:119], v[228:231], a[96:99], v[116:119]
    ds_read_b128 v[236:239], v11 offset:2048
    s_waitcnt lgkmcnt(4)
    v_mfma_f32_16x16x32_bf16 v[92:95], v[224:227], a[92:95], v[92:95]
    buffer_load_dwordx4 a[164:167], v2, s[48:51], s25 offen offset:1024 sc1
    v_mfma_f32_16x16x32_bf16 v[120:123], v[224:227], a[96:99], v[120:123]
    ds_read_b128 v[232:235], v11 offset:22528
    v_mfma_f32_16x16x32_bf16 v[96:99], v[220:223], a[92:95], v[96:99]
    v_mfma_f32_16x16x32_bf16 v[124:127], v[220:223], a[96:99], v[124:127]
    ds_read_b128 v[228:231], v11 offset:43008
    s_waitcnt lgkmcnt(4) vmcnt(13)
    v_mfma_f32_16x16x32_bf16 v[72:75], v[216:219], a[100:103], v[72:75]
    buffer_load_dwordx4 a[92:95], v2, s[48:51], s64 offen offset:3072 sc1
    v_mfma_f32_16x16x32_bf16 v[100:103], v[216:219], a[136:139], v[100:103]
    ds_read_b128 v[224:227], v12 offset:2048
    v_mfma_f32_16x16x32_bf16 v[76:79], v[212:215], a[100:103], v[76:79]
    v_mfma_f32_16x16x32_bf16 v[104:107], v[212:215], a[136:139], v[104:107]
    ds_read_b128 v[220:223], v2 offset:3072
    s_waitcnt lgkmcnt(4)
    v_mfma_f32_16x16x32_bf16 v[80:83], v[240:243], a[100:103], v[80:83]
    buffer_load_dwordx4 a[96:99], v2, s[48:51], s65 offen offset:3072 sc1
    v_mfma_f32_16x16x32_bf16 v[108:111], v[240:243], a[136:139], v[108:111]
    ds_read_b128 v[216:219], v2 offset:23552
    s_add_u32 s64, s64, 4096
    v_mfma_f32_16x16x32_bf16 v[84:87], v[236:239], a[100:103], v[84:87]
    s_add_u32 s65, s65, 4096
    v_mfma_f32_16x16x32_bf16 v[112:115], v[236:239], a[136:139], v[112:115]
    ds_read_b128 v[212:215], v2 offset:44032
    s_waitcnt lgkmcnt(4)
    v_mfma_f32_16x16x32_bf16 v[88:91], v[232:235], a[100:103], v[88:91]
    buffer_load_dwordx4 a[168:171], v2, s[48:51], s25 offen offset:2048 sc1
    v_mfma_f32_16x16x32_bf16 v[116:119], v[232:235], a[136:139], v[116:119]
    ds_read_b128 v[240:243], v11 offset:3072
    v_mfma_f32_16x16x32_bf16 v[92:95], v[228:231], a[100:103], v[92:95]
    v_mfma_f32_16x16x32_bf16 v[120:123], v[228:231], a[136:139], v[120:123]
    ds_read_b128 v[236:239], v11 offset:23552
    s_waitcnt lgkmcnt(4)
    v_mfma_f32_16x16x32_bf16 v[96:99], v[224:227], a[100:103], v[96:99]
    buffer_load_dwordx4 a[100:103], v2, s[48:51], s64 offen offset:0 sc1
    v_mfma_f32_16x16x32_bf16 v[124:127], v[224:227], a[136:139], v[124:127]
    ds_read_b128 v[232:235], v11 offset:44032
    s_waitcnt vmcnt(15)
    v_mfma_f32_16x16x32_bf16 v[72:75], v[220:223], a[140:143], v[72:75]
    v_mfma_f32_16x16x32_bf16 v[100:103], v[220:223], a[144:147], v[100:103]
    ds_read_b128 v[228:231], v12 offset:3072
    s_waitcnt lgkmcnt(4)
    v_mfma_f32_16x16x32_bf16 v[76:79], v[216:219], a[140:143], v[76:79]
    buffer_load_dwordx4 a[136:139], v2, s[48:51], s65 offen offset:0 sc1
    v_mfma_f32_16x16x32_bf16 v[104:107], v[216:219], a[144:147], v[104:107]
    ds_read_b128 v[224:227], v2 offset:4096
    v_mfma_f32_16x16x32_bf16 v[80:83], v[212:215], a[140:143], v[80:83]
    v_mfma_f32_16x16x32_bf16 v[108:111], v[212:215], a[144:147], v[108:111]
    ds_read_b128 v[220:223], v2 offset:24576
    s_waitcnt lgkmcnt(4)
    v_mfma_f32_16x16x32_bf16 v[84:87], v[240:243], a[140:143], v[84:87]
    buffer_load_dwordx4 a[172:175], v2, s[48:51], s25 offen offset:3072 sc1
    s_add_u32 s25, s25, 4096
    v_mfma_f32_16x16x32_bf16 v[112:115], v[240:243], a[144:147], v[112:115]
    ds_read_b128 v[216:219], v2 offset:45056
    v_mfma_f32_16x16x32_bf16 v[88:91], v[236:239], a[140:143], v[88:91]
    v_mfma_f32_16x16x32_bf16 v[116:119], v[236:239], a[144:147], v[116:119]
    ds_read_b128 v[212:215], v11 offset:4096
    s_waitcnt lgkmcnt(4)
    v_mfma_f32_16x16x32_bf16 v[92:95], v[232:235], a[140:143], v[92:95]
    buffer_load_dwordx4 a[176:179], v2, s[48:51], s25 offen offset:0 sc1
    v_mfma_f32_16x16x32_bf16 v[120:123], v[232:235], a[144:147], v[120:123]
    ds_read_b128 v[240:243], v11 offset:24576
    v_mfma_f32_16x16x32_bf16 v[96:99], v[228:231], a[140:143], v[96:99]
    v_mfma_f32_16x16x32_bf16 v[124:127], v[228:231], a[144:147], v[124:127]
    ds_read_b128 v[236:239], v11 offset:45056
    s_waitcnt lgkmcnt(4) vmcnt(15)
    v_mfma_f32_16x16x32_bf16 v[72:75], v[224:227], a[148:151], v[72:75]
    buffer_load_dwordx4 a[140:143], v2, s[48:51], s64 offen offset:1024 sc1
    v_mfma_f32_16x16x32_bf16 v[100:103], v[224:227], a[152:155], v[100:103]
    ds_read_b128 v[232:235], v12 offset:4096
    v_mfma_f32_16x16x32_bf16 v[76:79], v[220:223], a[148:151], v[76:79]
    v_mfma_f32_16x16x32_bf16 v[104:107], v[220:223], a[152:155], v[104:107]
    ds_read_b128 v[228:231], v2 offset:5120
    s_waitcnt lgkmcnt(4)
    v_mfma_f32_16x16x32_bf16 v[80:83], v[216:219], a[148:151], v[80:83]
    buffer_load_dwordx4 a[144:147], v2, s[48:51], s65 offen offset:1024 sc1
    v_mfma_f32_16x16x32_bf16 v[108:111], v[216:219], a[152:155], v[108:111]
    ds_read_b128 v[224:227], v2 offset:25600
    s_waitcnt vmcnt(16)
    v_add_f32 v248, v248, v250
    v_mfma_f32_16x16x32_bf16 v[84:87], v[212:215], a[148:151], v[84:87]
    v_add_f32 v249, v249, v251
    s_waitcnt vmcnt(12)
    v_add_f32 v252, v252, v254
    v_mfma_f32_16x16x32_bf16 v[112:115], v[212:215], a[152:155], v[112:115]
    ds_read_b128 v[220:223], v2 offset:46080
    s_waitcnt lgkmcnt(4)
    v_mfma_f32_16x16x32_bf16 v[88:91], v[240:243], a[148:151], v[88:91]
    buffer_load_dwordx4 a[180:183], v2, s[48:51], s64 offen offset:2048 sc1
    v_mfma_f32_16x16x32_bf16 v[116:119], v[240:243], a[152:155], v[116:119]
    ds_read_b128 v[216:219], v11 offset:5120
    v_add_f32 v253, v253, v255
    v_mfma_f32_16x16x32_bf16 v[92:95], v[236:239], a[148:151], v[92:95]
    v_mov_b32 v7, v248
    v_mov_b32 v8, v249
    v_mfma_f32_16x16x32_bf16 v[120:123], v[236:239], a[152:155], v[120:123]
    ds_read_b128 v[212:215], v11 offset:25600
    s_waitcnt lgkmcnt(4)
    v_mfma_f32_16x16x32_bf16 v[96:99], v[232:235], a[148:151], v[96:99]
    buffer_load_dwordx4 a[148:151], v2, s[48:51], s65 offen offset:2048 sc1
    v_mfma_f32_16x16x32_bf16 v[124:127], v[232:235], a[152:155], v[124:127]
    ds_read_b128 v[240:243], v11 offset:46080
    v_mov_b32 v9, v252
    v_mfma_f32_16x16x32_bf16 v[72:75], v[228:231], a[156:159], v[72:75]
    v_mov_b32 v10, v253
    v_permlane16_swap_b32 v7, v248
    v_mfma_f32_16x16x32_bf16 v[100:103], v[228:231], a[84:87], v[100:103]
    ds_read_b128 v[236:239], v12 offset:5120
    s_waitcnt lgkmcnt(4)
    v_mfma_f32_16x16x32_bf16 v[76:79], v[224:227], a[156:159], v[76:79]
    buffer_load_dwordx4 a[152:155], v2, s[48:51], s64 offen offset:3072 sc1
    v_mfma_f32_16x16x32_bf16 v[104:107], v[224:227], a[84:87], v[104:107]
    ds_read_b128 v[232:235], v2 offset:6144
    v_permlane16_swap_b32 v8, v249
    v_mfma_f32_16x16x32_bf16 v[80:83], v[220:223], a[156:159], v[80:83]
    v_permlane16_swap_b32 v9, v252
    v_permlane16_swap_b32 v10, v253
    v_mfma_f32_16x16x32_bf16 v[108:111], v[220:223], a[84:87], v[108:111]
    ds_read_b128 v[228:231], v2 offset:26624
    s_waitcnt lgkmcnt(4)
    v_mfma_f32_16x16x32_bf16 v[84:87], v[216:219], a[156:159], v[84:87]
    buffer_load_dwordx4 a[184:187], v2, s[48:51], s65 offen offset:3072 sc1
    v_mfma_f32_16x16x32_bf16 v[112:115], v[216:219], a[84:87], v[112:115]
    ds_read_b128 v[224:227], v2 offset:47104
    s_add_u32 s64, s64, 4096
    v_mfma_f32_16x16x32_bf16 v[88:91], v[212:215], a[156:159], v[88:91]
    s_add_u32 s65, s65, 4096
    v_add_f32 v248, v248, v7
    v_mfma_f32_16x16x32_bf16 v[116:119], v[212:215], a[84:87], v[116:119]
    ds_read_b128 v[220:223], v11 offset:6144
    s_waitcnt lgkmcnt(4)
    v_mfma_f32_16x16x32_bf16 v[92:95], v[240:243], a[156:159], v[92:95]
    buffer_load_dwordx4 a[188:191], v2, s[48:51], s64 offen offset:0 sc1
    v_mfma_f32_16x16x32_bf16 v[120:123], v[240:243], a[84:87], v[120:123]
    ds_read_b128 v[216:219], v11 offset:26624
    v_add_f32 v249, v249, v8
    v_mfma_f32_16x16x32_bf16 v[96:99], v[236:239], a[156:159], v[96:99]
    v_add_f32 v252, v252, v9
    v_add_f32 v253, v253, v10
    v_mfma_f32_16x16x32_bf16 v[124:127], v[236:239], a[84:87], v[124:127]
    ds_read_b128 v[212:215], v11 offset:47104
    s_waitcnt lgkmcnt(4) vmcnt(15)
    v_mfma_f32_16x16x32_bf16 v[72:75], v[232:235], a[88:91], v[72:75]
    buffer_load_dwordx4 a[84:87], v2, s[48:51], s65 offen offset:0 sc1
    v_mfma_f32_16x16x32_bf16 v[100:103], v[232:235], a[160:163], v[100:103]
    ds_read_b128 v[240:243], v12 offset:6144
    v_mov_b32 v7, v248
    v_mfma_f32_16x16x32_bf16 v[76:79], v[228:231], a[88:91], v[76:79]
    v_mov_b32 v8, v249
    v_mov_b32 v9, v252
    v_mfma_f32_16x16x32_bf16 v[104:107], v[228:231], a[160:163], v[104:107]
    ds_read_b128 v[236:239], v2 offset:7168
    s_waitcnt lgkmcnt(4)
    v_mfma_f32_16x16x32_bf16 v[80:83], v[224:227], a[88:91], v[80:83]
    buffer_load_dwordx4 a[156:159], v2, s[48:51], s64 offen offset:1024 sc1
    v_mfma_f32_16x16x32_bf16 v[108:111], v[224:227], a[160:163], v[108:111]
    ds_read_b128 v[232:235], v2 offset:27648
    v_mov_b32 v10, v253
    v_mfma_f32_16x16x32_bf16 v[84:87], v[220:223], a[88:91], v[84:87]
    v_permlane32_swap_b32 v7, v248
    v_permlane32_swap_b32 v8, v249
    v_mfma_f32_16x16x32_bf16 v[112:115], v[220:223], a[160:163], v[112:115]
    ds_read_b128 v[228:231], v2 offset:48128
    s_waitcnt lgkmcnt(4)
    v_mfma_f32_16x16x32_bf16 v[88:91], v[216:219], a[88:91], v[88:91]
    buffer_load_dwordx4 a[192:195], v2, s[48:51], s65 offen offset:1024 sc1
    v_mfma_f32_16x16x32_bf16 v[116:119], v[216:219], a[160:163], v[116:119]
    ds_read_b128 v[224:227], v11 offset:7168
    v_permlane32_swap_b32 v9, v252
    v_mfma_f32_16x16x32_bf16 v[92:95], v[212:215], a[88:91], v[92:95]
    v_permlane32_swap_b32 v10, v253
    v_add_f32 v248, v248, v7
    v_mfma_f32_16x16x32_bf16 v[120:123], v[212:215], a[160:163], v[120:123]
    ds_read_b128 v[220:223], v11 offset:27648
    s_waitcnt lgkmcnt(4)
    v_mfma_f32_16x16x32_bf16 v[96:99], v[240:243], a[88:91], v[96:99]
    buffer_load_dwordx4 a[88:91], v2, s[48:51], s64 offen offset:2048 sc1
    v_mfma_f32_16x16x32_bf16 v[124:127], v[240:243], a[160:163], v[124:127]
    ds_read_b128 v[216:219], v11 offset:48128
    v_add_f32 v249, v249, v8
    s_waitcnt vmcnt(16)
    v_mfma_f32_16x16x32_bf16 v[72:75], v[236:239], a[92:95], v[72:75]
    v_add_f32 v252, v252, v9
    v_add_f32 v253, v253, v10
    v_mfma_f32_16x16x32_bf16 v[100:103], v[236:239], a[96:99], v[100:103]
    ds_read_b128 v[212:215], v12 offset:7168
    s_waitcnt lgkmcnt(4)
    v_mfma_f32_16x16x32_bf16 v[76:79], v[232:235], a[92:95], v[76:79]
    buffer_load_dwordx4 a[160:163], v2, s[48:51], s65 offen offset:2048 sc1
    v_mfma_f32_16x16x32_bf16 v[104:107], v[232:235], a[96:99], v[104:107]
    ds_read_b128 v[240:243], v2 offset:8192
    v_mul_f32 v248, 0x3acccccd, v248
    v_mfma_f32_16x16x32_bf16 v[80:83], v[228:231], a[92:95], v[80:83]
    v_mul_f32 v252, 0x3acccccd, v252
    v_mul_f32 v249, 0x3acccccd, v249
    v_mfma_f32_16x16x32_bf16 v[108:111], v[228:231], a[96:99], v[108:111]
    ds_read_b128 v[236:239], v2 offset:28672
    s_waitcnt lgkmcnt(4)
    v_mfma_f32_16x16x32_bf16 v[84:87], v[224:227], a[92:95], v[84:87]
    buffer_load_dwordx4 a[196:199], v2, s[48:51], s64 offen offset:3072 sc1
    v_mfma_f32_16x16x32_bf16 v[112:115], v[224:227], a[96:99], v[112:115]
    ds_read_b128 v[232:235], v2 offset:49152
    v_mul_f32 v253, 0x3acccccd, v253
    v_mfma_f32_16x16x32_bf16 v[88:91], v[220:223], a[92:95], v[88:91]
    v_fma_f32 v249, -v248, v248, v249
    v_fma_f32 v253, -v252, v252, v253
    v_mfma_f32_16x16x32_bf16 v[116:119], v[220:223], a[96:99], v[116:119]
    ds_read_b128 v[228:231], v11 offset:8192
    s_waitcnt lgkmcnt(4)
    v_mfma_f32_16x16x32_bf16 v[92:95], v[216:219], a[92:95], v[92:95]
    buffer_load_dwordx4 a[200:203], v2, s[48:51], s65 offen offset:3072 sc1
    v_mfma_f32_16x16x32_bf16 v[120:123], v[216:219], a[96:99], v[120:123]
    ds_read_b128 v[224:227], v11 offset:28672
    s_add_u32 s64, s64, 4096
    v_mfma_f32_16x16x32_bf16 v[96:99], v[212:215], a[92:95], v[96:99]
    s_add_u32 s65, s65, 4096
    v_max_f32 v249, 0, v249
    v_mfma_f32_16x16x32_bf16 v[124:127], v[212:215], a[96:99], v[124:127]
    ds_read_b128 v[220:223], v11 offset:49152
    s_waitcnt lgkmcnt(4) vmcnt(16)
    v_mfma_f32_16x16x32_bf16 v[72:75], v[240:243], a[100:103], v[72:75]
    buffer_load_dwordx4 a[92:95], v2, s[48:51], s64 offen offset:0 sc1
    v_mfma_f32_16x16x32_bf16 v[100:103], v[240:243], a[136:139], v[100:103]
    ds_read_b128 v[216:219], v12 offset:8192
    v_max_f32 v253, 0, v253
    v_mfma_f32_16x16x32_bf16 v[76:79], v[236:239], a[100:103], v[76:79]
    v_add_f32 v249, 0x3727c5ac, v249
    v_add_f32 v253, 0x3727c5ac, v253
    v_mfma_f32_16x16x32_bf16 v[104:107], v[236:239], a[136:139], v[104:107]
    ds_read_b128 v[212:215], v2 offset:9216
    s_waitcnt lgkmcnt(4)
    v_mfma_f32_16x16x32_bf16 v[80:83], v[232:235], a[100:103], v[80:83]
    buffer_load_dwordx4 a[96:99], v2, s[48:51], s65 offen offset:0 sc1
    v_mfma_f32_16x16x32_bf16 v[108:111], v[232:235], a[136:139], v[108:111]
    ds_read_b128 v[240:243], v2 offset:29696
    v_rsq_f32 v16, v249
    v_mfma_f32_16x16x32_bf16 v[84:87], v[228:231], a[100:103], v[84:87]
    v_rsq_f32 v18, v253
    v_mfma_f32_16x16x32_bf16 v[112:115], v[228:231], a[136:139], v[112:115]
    ds_read_b128 v[236:239], v2 offset:50176
    s_waitcnt lgkmcnt(4)
    v_mfma_f32_16x16x32_bf16 v[88:91], v[224:227], a[100:103], v[88:91]
    buffer_load_dwordx4 a[204:207], v2, s[48:51], s64 offen offset:1024 sc1
    v_mfma_f32_16x16x32_bf16 v[116:119], v[224:227], a[136:139], v[116:119]
    ds_read_b128 v[232:235], v11 offset:9216
    v_mfma_f32_16x16x32_bf16 v[92:95], v[220:223], a[100:103], v[92:95]
    v_mul_f32_e64 v17, -v248, v16
    v_mul_f32_e64 v19, -v252, v18
    v_mfma_f32_16x16x32_bf16 v[120:123], v[220:223], a[136:139], v[120:123]
    ds_read_b128 v[228:231], v11 offset:29696
    s_waitcnt lgkmcnt(4)
    v_mfma_f32_16x16x32_bf16 v[96:99], v[216:219], a[100:103], v[96:99]
    buffer_load_dwordx4 a[100:103], v2, s[48:51], s65 offen offset:1024 sc1
    v_mfma_f32_16x16x32_bf16 v[124:127], v[216:219], a[136:139], v[124:127]
    ds_read_b128 v[224:227], v11 offset:50176
    v_fma_f32 v44, v184, v17, v128
    s_waitcnt vmcnt(16)
    v_mfma_f32_16x16x32_bf16 v[72:75], v[212:215], a[140:143], v[72:75]
    v_fma_f32 v184, v184, v19, v128
    v_fma_f32 v45, v185, v17, v129
    v_mfma_f32_16x16x32_bf16 v[100:103], v[212:215], a[144:147], v[100:103]
    ds_read_b128 v[220:223], v12 offset:9216
    s_waitcnt lgkmcnt(4)
    v_mfma_f32_16x16x32_bf16 v[76:79], v[240:243], a[140:143], v[76:79]
    buffer_load_dwordx4 a[136:139], v2, s[48:51], s64 offen offset:2048 sc1
    v_mfma_f32_16x16x32_bf16 v[104:107], v[240:243], a[144:147], v[104:107]
    ds_read_b128 v[216:219], v2 offset:10240
    v_fma_f32 v185, v185, v19, v129
    v_mfma_f32_16x16x32_bf16 v[80:83], v[236:239], a[140:143], v[80:83]
    v_fma_f32 v46, v186, v17, v130
    v_fma_f32 v186, v186, v19, v130
    v_mfma_f32_16x16x32_bf16 v[108:111], v[236:239], a[144:147], v[108:111]
    ds_read_b128 v[212:215], v2 offset:30720
    s_waitcnt lgkmcnt(4)
    v_mfma_f32_16x16x32_bf16 v[84:87], v[232:235], a[140:143], v[84:87]
    buffer_load_dwordx4 a[208:211], v2, s[48:51], s65 offen offset:2048 sc1
    v_mfma_f32_16x16x32_bf16 v[112:115], v[232:235], a[144:147], v[112:115]
    ds_read_b128 v[240:243], v2 offset:51200
    v_fma_f32 v47, v187, v17, v131
    v_mfma_f32_16x16x32_bf16 v[88:91], v[228:231], a[140:143], v[88:91]
    v_fma_f32 v187, v187, v19, v131
    v_fma_f32 v48, v188, v17, v132
    v_mfma_f32_16x16x32_bf16 v[116:119], v[228:231], a[144:147], v[116:119]
    ds_read_b128 v[236:239], v11 offset:10240
    s_waitcnt lgkmcnt(4)
    v_mfma_f32_16x16x32_bf16 v[92:95], v[224:227], a[140:143], v[92:95]
    buffer_load_dwordx4 a[212:215], v2, s[48:51], s64 offen offset:3072 sc1
    v_mfma_f32_16x16x32_bf16 v[120:123], v[224:227], a[144:147], v[120:123]
    ds_read_b128 v[232:235], v11 offset:30720
    v_fma_f32 v188, v188, v19, v132
    v_mfma_f32_16x16x32_bf16 v[96:99], v[220:223], a[140:143], v[96:99]
    v_fma_f32 v49, v189, v17, v133
    v_fma_f32 v189, v189, v19, v133
    v_mfma_f32_16x16x32_bf16 v[124:127], v[220:223], a[144:147], v[124:127]
    ds_read_b128 v[228:231], v11 offset:51200
    s_waitcnt lgkmcnt(4) vmcnt(17)
    v_mfma_f32_16x16x32_bf16 v[72:75], v[216:219], a[180:183], v[72:75]
    buffer_load_dwordx4 a[140:143], v2, s[48:51], s65 offen offset:3072 sc1
    v_mfma_f32_16x16x32_bf16 v[100:103], v[216:219], a[148:151], v[100:103]
    ds_read_b128 v[224:227], v12 offset:10240
    v_fma_f32 v50, v190, v17, v134
    v_mfma_f32_16x16x32_bf16 v[76:79], v[212:215], a[180:183], v[76:79]
    v_fma_f32 v190, v190, v19, v134
    v_fma_f32 v51, v191, v17, v135
    v_mfma_f32_16x16x32_bf16 v[104:107], v[212:215], a[148:151], v[104:107]
    ds_read_b128 v[220:223], v2 offset:11264
    s_waitcnt lgkmcnt(4)
    v_mfma_f32_16x16x32_bf16 v[80:83], v[240:243], a[180:183], v[80:83]
    buffer_load_dwordx4 a[144:147], v2, s[48:51], s25 offen offset:1024 sc1
    v_mfma_f32_16x16x32_bf16 v[108:111], v[240:243], a[148:151], v[108:111]
    ds_read_b128 v[216:219], v2 offset:31744
    v_fma_f32 v191, v191, v19, v135
    v_mfma_f32_16x16x32_bf16 v[84:87], v[236:239], a[180:183], v[84:87]
    v_fma_f32 v52, v192, v17, v136
    v_fma_f32 v192, v192, v19, v136
    v_mfma_f32_16x16x32_bf16 v[112:115], v[236:239], a[148:151], v[112:115]
    ds_read_b128 v[212:215], v2 offset:52224
    s_waitcnt lgkmcnt(4)
    v_mfma_f32_16x16x32_bf16 v[88:91], v[232:235], a[180:183], v[88:91]
    buffer_load_dwordx4 a[216:219], v2, s[48:51], s25 offen offset:2048 sc1
    v_mfma_f32_16x16x32_bf16 v[116:119], v[232:235], a[148:151], v[116:119]
    ds_read_b128 v[240:243], v11 offset:11264
    v_fma_f32 v53, v193, v17, v137
    v_mfma_f32_16x16x32_bf16 v[92:95], v[228:231], a[180:183], v[92:95]
    v_fma_f32 v193, v193, v19, v137
    v_fma_f32 v54, v194, v17, v138
    v_mfma_f32_16x16x32_bf16 v[120:123], v[228:231], a[148:151], v[120:123]
    ds_read_b128 v[236:239], v11 offset:31744
    s_waitcnt lgkmcnt(4)
    v_mfma_f32_16x16x32_bf16 v[96:99], v[224:227], a[180:183], v[96:99]
    buffer_load_dwordx4 a[180:183], v2, s[48:51], s25 offen offset:3072 sc1
    s_add_u32 s25, s25, 4096
    v_mfma_f32_16x16x32_bf16 v[124:127], v[224:227], a[148:151], v[124:127]
    ds_read_b128 v[232:235], v11 offset:52224
    v_fma_f32 v194, v194, v19, v138
    s_waitcnt vmcnt(19)
    v_mfma_f32_16x16x32_bf16 v[72:75], v[220:223], a[152:155], v[72:75]
    v_fma_f32 v55, v195, v17, v139
    v_fma_f32 v195, v195, v19, v139
    v_mfma_f32_16x16x32_bf16 v[100:103], v[220:223], a[184:187], v[100:103]
    ds_read_b128 v[228:231], v12 offset:11264
    s_waitcnt lgkmcnt(4)
    v_mfma_f32_16x16x32_bf16 v[76:79], v[216:219], a[152:155], v[76:79]
    buffer_load_dwordx4 a[148:151], v2, s[48:51], s25 offen offset:0 sc1
    v_mfma_f32_16x16x32_bf16 v[104:107], v[216:219], a[184:187], v[104:107]
    ds_read_b128 v[224:227], v2 offset:12288
    v_fma_f32 v56, v196, v17, v140
    v_mfma_f32_16x16x32_bf16 v[80:83], v[212:215], a[152:155], v[80:83]
    v_fma_f32 v196, v196, v19, v140
    v_fma_f32 v57, v197, v17, v141
    v_mfma_f32_16x16x32_bf16 v[108:111], v[212:215], a[184:187], v[108:111]
    ds_read_b128 v[220:223], v2 offset:32768
    s_waitcnt lgkmcnt(4)
    v_mfma_f32_16x16x32_bf16 v[84:87], v[240:243], a[152:155], v[84:87]
    buffer_load_dwordx4 a[220:223], v2, s[48:51], s25 offen offset:1024 sc1
    v_mfma_f32_16x16x32_bf16 v[112:115], v[240:243], a[184:187], v[112:115]
    ds_read_b128 v[216:219], v2 offset:53248
    v_fma_f32 v197, v197, v19, v141
    v_mfma_f32_16x16x32_bf16 v[88:91], v[236:239], a[152:155], v[88:91]
    v_fma_f32 v58, v198, v17, v142
    v_fma_f32 v198, v198, v19, v142
    v_mfma_f32_16x16x32_bf16 v[116:119], v[236:239], a[184:187], v[116:119]
    ds_read_b128 v[212:215], v11 offset:12288
    s_waitcnt lgkmcnt(4)
    v_mfma_f32_16x16x32_bf16 v[92:95], v[232:235], a[152:155], v[92:95]
    buffer_load_dwordx4 a[224:227], v2, s[48:51], s25 offen offset:2048 sc1
    v_mfma_f32_16x16x32_bf16 v[120:123], v[232:235], a[184:187], v[120:123]
    ds_read_b128 v[240:243], v11 offset:32768
    v_fma_f32 v59, v199, v17, v143
    v_mfma_f32_16x16x32_bf16 v[96:99], v[228:231], a[152:155], v[96:99]
    v_fma_f32 v199, v199, v19, v143
    v_fma_f32 v60, v200, v17, v144
    v_mfma_f32_16x16x32_bf16 v[124:127], v[228:231], a[184:187], v[124:127]
    ds_read_b128 v[236:239], v11 offset:53248
    s_waitcnt lgkmcnt(4)
    s_cmp_lg_u32 s3, 1
    s_cbranch_scc1 L_nopf_87
    s_getpc_b64 s[52:53]
L_pc_88:
    s_and_b32 s52, s52, 0xffffff00
    s_mov_b32 s54, L_end-L_pc_88
    s_mov_b32 s55, 0x20000
    s_lshr_b32 s10, s2, 3
    s_lshl_b32 s10, s10, 8
    v_lshlrev_b32 v6, 2, v1
    v_add_u32 v6, s10, v6
    buffer_load_dword v6, v6, s[52:55], 0 offen
L_nopf_87:
    s_waitcnt vmcnt(20)
    v_mfma_f32_16x16x32_bf16 v[72:75], v[224:227], a[188:191], v[72:75]
    buffer_load_dwordx4 a[152:155], v2, s[48:51], s25 offen offset:3072 sc1
    s_add_u32 s25, s25, 4096
    v_mfma_f32_16x16x32_bf16 v[100:103], v[224:227], a[84:87], v[100:103]
    ds_read_b128 v[232:235], v12 offset:12288
    v_fma_f32 v200, v200, v19, v144
    v_mfma_f32_16x16x32_bf16 v[76:79], v[220:223], a[188:191], v[76:79]
    v_fma_f32 v61, v201, v17, v145
    v_fma_f32 v201, v201, v19, v145
    v_mfma_f32_16x16x32_bf16 v[104:107], v[220:223], a[84:87], v[104:107]
    ds_read_b128 v[228:231], v2 offset:13312
    s_waitcnt lgkmcnt(4)
    v_mfma_f32_16x16x32_bf16 v[80:83], v[216:219], a[188:191], v[80:83]
    buffer_load_dwordx4 a[184:187], v2, s[48:51], s25 offen offset:0 sc1
    v_mfma_f32_16x16x32_bf16 v[108:111], v[216:219], a[84:87], v[108:111]
    ds_read_b128 v[224:227], v2 offset:33792
    v_fma_f32 v62, v202, v17, v146
    v_mfma_f32_16x16x32_bf16 v[84:87], v[212:215], a[188:191], v[84:87]
    v_fma_f32 v202, v202, v19, v146
    v_fma_f32 v63, v203, v17, v147
    v_mfma_f32_16x16x32_bf16 v[112:115], v[212:215], a[84:87], v[112:115]
    ds_read_b128 v[220:223], v2 offset:14336
    s_waitcnt lgkmcnt(4)
    v_mfma_f32_16x16x32_bf16 v[88:91], v[240:243], a[188:191], v[88:91]
    buffer_load_dwordx4 a[228:231], v2, s[48:51], s25 offen offset:1024 sc1
    v_mfma_f32_16x16x32_bf16 v[116:119], v[240:243], a[84:87], v[116:119]
    ds_read_b128 v[216:219], v2 offset:34816
    v_fma_f32 v203, v203, v19, v147
    v_mfma_f32_16x16x32_bf16 v[92:95], v[236:239], a[188:191], v[92:95]
    v_fma_f32 v64, v204, v17, v148
    v_fma_f32 v204, v204, v19, v148
    v_mfma_f32_16x16x32_bf16 v[120:123], v[236:239], a[84:87], v[120:123]
    ds_read_b128 v[212:215], v2 offset:15360
    s_waitcnt lgkmcnt(4)
    v_mfma_f32_16x16x32_bf16 v[96:99], v[232:235], a[188:191], v[96:99]
    buffer_load_dwordx4 a[188:191], v2, s[48:51], s25 offen offset:2048 sc1
    v_mfma_f32_16x16x32_bf16 v[124:127], v[232:235], a[84:87], v[124:127]
    ds_read_b128 v[240:243], v2 offset:35840
    v_fma_f32 v65, v205, v17, v149
    s_waitcnt vmcnt(22)
    v_mfma_f32_16x16x32_bf16 v[72:75], v[228:231], a[156:159], v[72:75]
    v_fma_f32 v205, v205, v19, v149
    v_fma_f32 v66, v206, v17, v150
    v_mfma_f32_16x16x32_bf16 v[100:103], v[228:231], a[192:195], v[100:103]
    ds_read_b128 v[236:239], v2 offset:16384
    s_waitcnt lgkmcnt(4)
    v_mfma_f32_16x16x32_bf16 v[76:79], v[224:227], a[156:159], v[76:79]
    buffer_load_dwordx4 a[84:87], v2, s[48:51], s25 offen offset:3072 sc1
    s_add_u32 s25, s25, 4096
    v_mfma_f32_16x16x32_bf16 v[104:107], v[224:227], a[192:195], v[104:107]
    ds_read_b128 v[232:235], v2 offset:36864
    v_fma_f32 v206, v206, v19, v150
    s_waitcnt vmcnt(21)
    v_mfma_f32_16x16x32_bf16 v[72:75], v[220:223], a[88:91], v[72:75]
    v_fma_f32 v67, v207, v17, v151
    v_fma_f32 v207, v207, v19, v151
    v_mfma_f32_16x16x32_bf16 v[100:103], v[220:223], a[160:163], v[100:103]
    ds_read_b128 v[228:231], v2 offset:17408
    s_waitcnt lgkmcnt(4)
    v_mfma_f32_16x16x32_bf16 v[76:79], v[216:219], a[88:91], v[76:79]
    buffer_load_dwordx4 a[232:235], v2, s[48:51], s25 offen offset:0 sc1
    v_mfma_f32_16x16x32_bf16 v[104:107], v[216:219], a[160:163], v[104:107]
    ds_read_b128 v[224:227], v2 offset:37888
    v_fma_f32 v68, v208, v17, v152
    s_waitcnt vmcnt(20)
    v_mfma_f32_16x16x32_bf16 v[72:75], v[212:215], a[196:199], v[72:75]
    v_fma_f32 v208, v208, v19, v152
    v_fma_f32 v69, v209, v17, v153
    v_mfma_f32_16x16x32_bf16 v[100:103], v[212:215], a[200:203], v[100:103]
    ds_read_b128 v[220:223], v2 offset:18432
    s_waitcnt lgkmcnt(4)
    v_mfma_f32_16x16x32_bf16 v[76:79], v[240:243], a[196:199], v[76:79]
    buffer_load_dwordx4 a[236:239], v2, s[48:51], s25 offen offset:1024 sc1
    v_mfma_f32_16x16x32_bf16 v[104:107], v[240:243], a[200:203], v[104:107]
    ds_read_b128 v[216:219], v2 offset:38912
    v_fma_f32 v209, v209, v19, v153
    s_waitcnt vmcnt(19)
    v_mfma_f32_16x16x32_bf16 v[72:75], v[236:239], a[92:95], v[72:75]
    v_fma_f32 v70, v210, v17, v154
    v_fma_f32 v210, v210, v19, v154
    v_mfma_f32_16x16x32_bf16 v[100:103], v[236:239], a[96:99], v[100:103]
    ds_read_b128 v[212:215], v2 offset:19456
    s_waitcnt lgkmcnt(4)
    v_mfma_f32_16x16x32_bf16 v[76:79], v[232:235], a[92:95], v[76:79]
    buffer_load_dwordx4 a[240:243], v2, s[48:51], s25 offen offset:2048 sc1
    v_mfma_f32_16x16x32_bf16 v[104:107], v[232:235], a[96:99], v[104:107]
    ds_read_b128 v[240:243], v2 offset:39936
    v_fma_f32 v71, v211, v17, v155
    s_waitcnt vmcnt(18)
    v_mfma_f32_16x16x32_bf16 v[72:75], v[228:231], a[204:207], v[72:75]
    v_fma_f32 v211, v211, v19, v155
    v_mfma_f32_16x16x32_bf16 v[100:103], v[228:231], a[100:103], v[100:103]
    ds_read_b128 v[236:239], v2 offset:54272
    s_waitcnt lgkmcnt(4)
    v_mfma_f32_16x16x32_bf16 v[76:79], v[224:227], a[204:207], v[76:79]
    buffer_load_dwordx4 a[244:247], v2, s[48:51], s25 offen offset:3072 sc1
    s_add_u32 s25, s25, 4096
    v_mfma_f32_16x16x32_bf16 v[104:107], v[224:227], a[100:103], v[104:107]
    ds_read_b128 v[232:235], v11 offset:13312
    s_waitcnt vmcnt(17)
    v_mfma_f32_16x16x32_bf16 v[72:75], v[220:223], a[136:139], v[72:75]
    v_mfma_f32_16x16x32_bf16 v[100:103], v[220:223], a[208:211], v[100:103]
    ds_read_b128 v[228:231], v2 offset:55296
    s_waitcnt lgkmcnt(4)
    v_mfma_f32_16x16x32_bf16 v[76:79], v[216:219], a[136:139], v[76:79]
    buffer_load_dwordx4 a[248:251], v2, s[48:51], s25 offen offset:0 sc1
    v_mfma_f32_16x16x32_bf16 v[104:107], v[216:219], a[208:211], v[104:107]
    ds_read_b128 v[224:227], v11 offset:14336
    s_waitcnt vmcnt(16)
    v_mfma_f32_16x16x32_bf16 v[72:75], v[212:215], a[212:215], v[72:75]
    v_mfma_f32_16x16x32_bf16 v[100:103], v[212:215], a[140:143], v[100:103]
    ds_read_b128 v[220:223], v2 offset:56320
    s_waitcnt lgkmcnt(4)
    v_mfma_f32_16x16x32_bf16 v[76:79], v[240:243], a[212:215], v[76:79]
    v_mfma_f32_16x16x32_bf16 v[104:107], v[240:243], a[140:143], v[104:107]
    ds_read_b128 v[216:219], v11 offset:15360
    v_mfma_f32_16x16x32_bf16 v[80:83], v[236:239], a[156:159], v[80:83]
    v_mfma_f32_16x16x32_bf16 v[108:111], v[236:239], a[192:195], v[108:111]
    ds_read_b128 v[212:215], v2 offset:57344
    s_waitcnt lgkmcnt(4)
    v_mfma_f32_16x16x32_bf16 v[84:87], v[232:235], a[156:159], v[84:87]
    v_mfma_f32_16x16x32_bf16 v[112:115], v[232:235], a[192:195], v[112:115]
    ds_read_b128 v[240:243], v11 offset:16384
    v_mfma_f32_16x16x32_bf16 v[80:83], v[228:231], a[88:91], v[80:83]
    v_fma_f32 v72, v72, v16, v44
    v_fma_f32 v73, v73, v16, v45
    v_max_f32 v72, 0, v72
    v_max_f32 v73, 0, v73
    v_mul_f32 v72, v72, v72
    v_mfma_f32_16x16x32_bf16 v[108:111], v[228:231], a[160:163], v[108:111]
    ds_read_b128 v[236:239], v2 offset:58368
    s_waitcnt lgkmcnt(4)
    v_mfma_f32_16x16x32_bf16 v[84:87], v[224:227], a[88:91], v[84:87]
    v_mul_f32 v73, v73, v73
    v_cvt_pk_bf16_f32 v128, v72, v73
    v_fma_f32 v74, v74, v16, v46
    v_fma_f32 v75, v75, v16, v47
    v_max_f32 v74, 0, v74
    v_mfma_f32_16x16x32_bf16 v[112:115], v[224:227], a[160:163], v[112:115]
    ds_read_b128 v[232:235], v11 offset:17408
    v_max_f32 v75, 0, v75
    v_mfma_f32_16x16x32_bf16 v[80:83], v[220:223], a[196:199], v[80:83]
    v_mul_f32 v74, v74, v74
    v_mul_f32 v75, v75, v75
    v_cvt_pk_bf16_f32 v129, v74, v75
    v_fma_f32 v76, v76, v16, v48
    v_fma_f32 v77, v77, v16, v49
    v_mfma_f32_16x16x32_bf16 v[108:111], v[220:223], a[200:203], v[108:111]
    ds_read_b128 v[228:231], v2 offset:59392
    s_waitcnt lgkmcnt(4)
    v_mfma_f32_16x16x32_bf16 v[84:87], v[216:219], a[196:199], v[84:87]
    v_max_f32 v76, 0, v76
    v_max_f32 v77, 0, v77
    v_mul_f32 v76, v76, v76
    v_mul_f32 v77, v77, v77
    v_cvt_pk_bf16_f32 v130, v76, v77
    v_mfma_f32_16x16x32_bf16 v[112:115], v[216:219], a[200:203], v[112:115]
    ds_read_b128 v[224:227], v11 offset:18432
    v_fma_f32 v78, v78, v16, v50
    v_mfma_f32_16x16x32_bf16 v[80:83], v[212:215], a[92:95], v[80:83]
    v_fma_f32 v79, v79, v16, v51
    v_max_f32 v78, 0, v78
    v_max_f32 v79, 0, v79
    v_mul_f32 v78, v78, v78
    v_mul_f32 v79, v79, v79
    v_mfma_f32_16x16x32_bf16 v[108:111], v[212:215], a[96:99], v[108:111]
    ds_read_b128 v[220:223], v2 offset:60416
    s_waitcnt lgkmcnt(4)
    v_mfma_f32_16x16x32_bf16 v[84:87], v[240:243], a[92:95], v[84:87]
    v_cvt_pk_bf16_f32 v131, v78, v79
    v_fma_f32 v100, v100, v18, v184
    v_fma_f32 v101, v101, v18, v185
    buffer_store_dwordx4 v[128:131], v2, s[48:51], s67 offen offset:0 sc1
    v_mfma_f32_16x16x32_bf16 v[112:115], v[240:243], a[96:99], v[112:115]
    ds_read_b128 v[216:219], v11 offset:19456
    v_max_f32 v100, 0, v100
    v_mfma_f32_16x16x32_bf16 v[80:83], v[236:239], a[204:207], v[80:83]
    v_max_f32 v101, 0, v101
    v_mul_f32 v100, v100, v100
    v_mul_f32 v101, v101, v101
    v_cvt_pk_bf16_f32 v140, v100, v101
    v_fma_f32 v102, v102, v18, v186
    v_mfma_f32_16x16x32_bf16 v[108:111], v[236:239], a[100:103], v[108:111]
    ds_read_b128 v[212:215], v11 offset:33792
    s_waitcnt lgkmcnt(4)
    v_mfma_f32_16x16x32_bf16 v[84:87], v[232:235], a[204:207], v[84:87]
    v_fma_f32 v103, v103, v18, v187
    v_max_f32 v102, 0, v102
    v_max_f32 v103, 0, v103
    v_mul_f32 v102, v102, v102
    v_mul_f32 v103, v103, v103
    v_mfma_f32_16x16x32_bf16 v[112:115], v[232:235], a[100:103], v[112:115]
    ds_read_b128 v[240:243], v11 offset:54272
    v_cvt_pk_bf16_f32 v141, v102, v103
    v_mfma_f32_16x16x32_bf16 v[80:83], v[228:231], a[136:139], v[80:83]
    v_fma_f32 v104, v104, v18, v188
    v_fma_f32 v105, v105, v18, v189
    v_max_f32 v104, 0, v104
    v_max_f32 v105, 0, v105
    v_mul_f32 v104, v104, v104
    v_mfma_f32_16x16x32_bf16 v[108:111], v[228:231], a[208:211], v[108:111]
    ds_read_b128 v[236:239], v11 offset:34816
    s_waitcnt lgkmcnt(4)
    v_mfma_f32_16x16x32_bf16 v[84:87], v[224:227], a[136:139], v[84:87]
    v_mul_f32 v105, v105, v105
    v_cvt_pk_bf16_f32 v142, v104, v105
    v_fma_f32 v106, v106, v18, v190
    v_fma_f32 v107, v107, v18, v191
    v_max_f32 v106, 0, v106
    v_mfma_f32_16x16x32_bf16 v[112:115], v[224:227], a[208:211], v[112:115]
    ds_read_b128 v[232:235], v11 offset:55296
    v_max_f32 v107, 0, v107
    v_mfma_f32_16x16x32_bf16 v[80:83], v[220:223], a[212:215], v[80:83]
    v_mul_f32 v106, v106, v106
    v_mul_f32 v107, v107, v107
    v_cvt_pk_bf16_f32 v143, v106, v107
    buffer_store_dwordx4 v[140:143], v2, s[48:51], s71 offen offset:0 sc1
    v_mfma_f32_16x16x32_bf16 v[108:111], v[220:223], a[140:143], v[108:111]
    ds_read_b128 v[228:231], v11 offset:35840
    s_waitcnt lgkmcnt(4)
    v_mfma_f32_16x16x32_bf16 v[84:87], v[216:219], a[212:215], v[84:87]
    v_mfma_f32_16x16x32_bf16 v[112:115], v[216:219], a[140:143], v[112:115]
    ds_read_b128 v[224:227], v11 offset:56320
    v_mfma_f32_16x16x32_bf16 v[88:91], v[212:215], a[156:159], v[88:91]
    v_mfma_f32_16x16x32_bf16 v[116:119], v[212:215], a[192:195], v[116:119]
    ds_read_b128 v[220:223], v11 offset:36864
    s_waitcnt lgkmcnt(4)
    v_mfma_f32_16x16x32_bf16 v[92:95], v[240:243], a[156:159], v[92:95]
    v_mfma_f32_16x16x32_bf16 v[120:123], v[240:243], a[192:195], v[120:123]
    ds_read_b128 v[216:219], v11 offset:57344
    v_mfma_f32_16x16x32_bf16 v[88:91], v[236:239], a[88:91], v[88:91]
    v_fma_f32 v80, v80, v16, v52
    v_fma_f32 v81, v81, v16, v53
    v_max_f32 v80, 0, v80
    v_max_f32 v81, 0, v81
    v_mul_f32 v80, v80, v80
    v_mfma_f32_16x16x32_bf16 v[116:119], v[236:239], a[160:163], v[116:119]
    ds_read_b128 v[212:215], v11 offset:37888
    s_waitcnt lgkmcnt(4)
    v_mfma_f32_16x16x32_bf16 v[92:95], v[232:235], a[88:91], v[92:95]
    v_mul_f32 v81, v81, v81
    v_cvt_pk_bf16_f32 v132, v80, v81
    v_fma_f32 v82, v82, v16, v54
    v_fma_f32 v83, v83, v16, v55
    v_max_f32 v82, 0, v82
    v_mfma_f32_16x16x32_bf16 v[120:123], v[232:235], a[160:163], v[120:123]
    ds_read_b128 v[240:243], v11 offset:58368
    v_max_f32 v83, 0, v83
    v_mfma_f32_16x16x32_bf16 v[88:91], v[228:231], a[196:199], v[88:91]
    v_mul_f32 v82, v82, v82
    v_mul_f32 v83, v83, v83
    v_cvt_pk_bf16_f32 v133, v82, v83
    v_fma_f32 v84, v84, v16, v56
    v_fma_f32 v85, v85, v16, v57
    v_mfma_f32_16x16x32_bf16 v[116:119], v[228:231], a[200:203], v[116:119]
    ds_read_b128 v[236:239], v11 offset:38912
    s_waitcnt lgkmcnt(4)
    v_mfma_f32_16x16x32_bf16 v[92:95], v[224:227], a[196:199], v[92:95]
    v_max_f32 v84, 0, v84
    v_max_f32 v85, 0, v85
    v_mul_f32 v84, v84, v84
    v_mul_f32 v85, v85, v85
    v_cvt_pk_bf16_f32 v134, v84, v85
    v_mfma_f32_16x16x32_bf16 v[120:123], v[224:227], a[200:203], v[120:123]
    ds_read_b128 v[232:235], v11 offset:59392
    v_fma_f32 v86, v86, v16, v58
    v_mfma_f32_16x16x32_bf16 v[88:91], v[220:223], a[92:95], v[88:91]
    v_fma_f32 v87, v87, v16, v59
    v_max_f32 v86, 0, v86
    v_max_f32 v87, 0, v87
    v_mul_f32 v86, v86, v86
    v_mul_f32 v87, v87, v87
    v_mfma_f32_16x16x32_bf16 v[116:119], v[220:223], a[96:99], v[116:119]
    ds_read_b128 v[228:231], v11 offset:39936
    s_waitcnt lgkmcnt(4)
    v_mfma_f32_16x16x32_bf16 v[92:95], v[216:219], a[92:95], v[92:95]
    v_cvt_pk_bf16_f32 v135, v86, v87
    v_fma_f32 v108, v108, v18, v192
    v_fma_f32 v109, v109, v18, v193
    buffer_store_dwordx4 v[132:135], v2, s[48:51], s67 offen offset:1024 sc1
    v_mfma_f32_16x16x32_bf16 v[120:123], v[216:219], a[96:99], v[120:123]
    ds_read_b128 v[224:227], v11 offset:60416
    v_max_f32 v108, 0, v108
    v_mfma_f32_16x16x32_bf16 v[88:91], v[212:215], a[204:207], v[88:91]
    v_max_f32 v109, 0, v109
    v_mul_f32 v108, v108, v108
    v_mul_f32 v109, v109, v109
    v_cvt_pk_bf16_f32 v144, v108, v109
    v_fma_f32 v110, v110, v18, v194
    v_mfma_f32_16x16x32_bf16 v[116:119], v[212:215], a[100:103], v[116:119]
    ds_read_b128 v[220:223], v12 offset:13312
    s_waitcnt lgkmcnt(4)
    v_mfma_f32_16x16x32_bf16 v[92:95], v[240:243], a[204:207], v[92:95]
    v_fma_f32 v111, v111, v18, v195
    v_max_f32 v110, 0, v110
    v_max_f32 v111, 0, v111
    v_mul_f32 v110, v110, v110
    v_mul_f32 v111, v111, v111
    v_mfma_f32_16x16x32_bf16 v[120:123], v[240:243], a[100:103], v[120:123]
    ds_read_b128 v[216:219], v12 offset:14336
    v_cvt_pk_bf16_f32 v145, v110, v111
    v_mfma_f32_16x16x32_bf16 v[88:91], v[236:239], a[136:139], v[88:91]
    v_fma_f32 v112, v112, v18, v196
    v_fma_f32 v113, v113, v18, v197
    v_max_f32 v112, 0, v112
    v_max_f32 v113, 0, v113
    v_mul_f32 v112, v112, v112
    v_mfma_f32_16x16x32_bf16 v[116:119], v[236:239], a[208:211], v[116:119]
    ds_read_b128 v[212:215], v12 offset:15360
    s_waitcnt lgkmcnt(4)
    v_mfma_f32_16x16x32_bf16 v[92:95], v[232:235], a[136:139], v[92:95]
    v_mul_f32 v113, v113, v113
    v_cvt_pk_bf16_f32 v146, v112, v113
    v_fma_f32 v114, v114, v18, v198
    v_fma_f32 v115, v115, v18, v199
    v_max_f32 v114, 0, v114
    v_mfma_f32_16x16x32_bf16 v[120:123], v[232:235], a[208:211], v[120:123]
    ds_read_b128 v[240:243], v12 offset:16384
    v_max_f32 v115, 0, v115
    v_mfma_f32_16x16x32_bf16 v[88:91], v[228:231], a[212:215], v[88:91]
    v_mul_f32 v114, v114, v114
    v_mul_f32 v115, v115, v115
    v_cvt_pk_bf16_f32 v147, v114, v115
    buffer_store_dwordx4 v[144:147], v2, s[48:51], s71 offen offset:1024 sc1
    v_mfma_f32_16x16x32_bf16 v[116:119], v[228:231], a[140:143], v[116:119]
    ds_read_b128 v[236:239], v12 offset:17408
    s_waitcnt lgkmcnt(4)
    v_mfma_f32_16x16x32_bf16 v[92:95], v[224:227], a[212:215], v[92:95]
    v_mfma_f32_16x16x32_bf16 v[120:123], v[224:227], a[140:143], v[120:123]
    ds_read_b128 v[232:235], v12 offset:18432
    v_mfma_f32_16x16x32_bf16 v[96:99], v[220:223], a[156:159], v[96:99]
    v_mfma_f32_16x16x32_bf16 v[124:127], v[220:223], a[192:195], v[124:127]
    ds_read_b128 v[228:231], v12 offset:19456
    s_waitcnt lgkmcnt(4)
    v_mfma_f32_16x16x32_bf16 v[96:99], v[216:219], a[88:91], v[96:99]
    v_mfma_f32_16x16x32_bf16 v[124:127], v[216:219], a[160:163], v[124:127]
    v_mfma_f32_16x16x32_bf16 v[96:99], v[212:215], a[196:199], v[96:99]
    v_fma_f32 v88, v88, v16, v60
    v_fma_f32 v89, v89, v16, v61
    v_max_f32 v88, 0, v88
    v_max_f32 v89, 0, v89
    v_mul_f32 v88, v88, v88
    v_mfma_f32_16x16x32_bf16 v[124:127], v[212:215], a[200:203], v[124:127]
    v_mul_f32 v89, v89, v89
    s_waitcnt lgkmcnt(2)
    v_mfma_f32_16x16x32_bf16 v[96:99], v[240:243], a[92:95], v[96:99]
    v_cvt_pk_bf16_f32 v136, v88, v89
    v_fma_f32 v90, v90, v16, v62
    v_fma_f32 v91, v91, v16, v63
    v_max_f32 v90, 0, v90
    v_max_f32 v91, 0, v91
    v_mfma_f32_16x16x32_bf16 v[124:127], v[240:243], a[96:99], v[124:127]
    v_mul_f32 v90, v90, v90
    v_mul_f32 v91, v91, v91
    v_mfma_f32_16x16x32_bf16 v[96:99], v[236:239], a[204:207], v[96:99]
    v_cvt_pk_bf16_f32 v137, v90, v91
    v_fma_f32 v92, v92, v16, v64
    v_fma_f32 v93, v93, v16, v65
    v_max_f32 v92, 0, v92
    v_max_f32 v93, 0, v93
    v_mfma_f32_16x16x32_bf16 v[124:127], v[236:239], a[100:103], v[124:127]
    v_mul_f32 v92, v92, v92
    s_waitcnt lgkmcnt(0)
    v_mfma_f32_16x16x32_bf16 v[96:99], v[232:235], a[136:139], v[96:99]
    v_mul_f32 v93, v93, v93
    v_cvt_pk_bf16_f32 v138, v92, v93
    v_fma_f32 v94, v94, v16, v66
    v_fma_f32 v95, v95, v16, v67
    v_max_f32 v94, 0, v94
    v_mfma_f32_16x16x32_bf16 v[124:127], v[232:235], a[208:211], v[124:127]
    v_max_f32 v95, 0, v95
    v_mul_f32 v94, v94, v94
    v_mfma_f32_16x16x32_bf16 v[96:99], v[228:231], a[212:215], v[96:99]
    v_mul_f32 v95, v95, v95
    v_cvt_pk_bf16_f32 v139, v94, v95
    v_fma_f32 v116, v116, v18, v200
    buffer_store_dwordx4 v[136:139], v2, s[48:51], s67 offen offset:2048 sc1
    v_mfma_f32_16x16x32_bf16 v[124:127], v[228:231], a[140:143], v[124:127]
    v_fma_f32 v117, v117, v18, v201
    v_max_f32 v116, 0, v116
    v_max_f32 v117, 0, v117
    v_mul_f32 v116, v116, v116
    v_mul_f32 v117, v117, v117
    v_cvt_pk_bf16_f32 v148, v116, v117
    v_pk_fma_f32 v[118:119], v[118:119], v[18:19], v[202:203] op_sel_hi:[1,0,1]
    v_pk_fma_f32 v[120:121], v[120:121], v[18:19], v[204:205] op_sel_hi:[1,0,1]
    v_max_f32 v118, 0, v118
    v_max_f32 v119, 0, v119
    v_max_f32 v120, 0, v120
    v_max_f32 v121, 0, v121
    v_pk_mul_f32 v[118:119], v[118:119], v[118:119]
    v_pk_mul_f32 v[120:121], v[120:121], v[120:121]
    v_cvt_pk_bf16_f32 v149, v118, v119
    v_cvt_pk_bf16_f32 v150, v120, v121
    v_pk_fma_f32 v[122:123], v[122:123], v[18:19], v[206:207] op_sel_hi:[1,0,1]
    v_pk_fma_f32 v[96:97], v[96:97], v[16:17], v[68:69] op_sel_hi:[1,0,1]
    v_max_f32 v122, 0, v122
    v_max_f32 v123, 0, v123
    v_max_f32 v96, 0, v96
    v_max_f32 v97, 0, v97
    v_pk_mul_f32 v[122:123], v[122:123], v[122:123]
    v_pk_mul_f32 v[96:97], v[96:97], v[96:97]
    v_cvt_pk_bf16_f32 v151, v122, v123
    buffer_store_dwordx4 v[148:151], v2, s[48:51], s71 offen offset:2048 sc1
    v_cvt_pk_bf16_f32 v152, v96, v97
    v_pk_fma_f32 v[98:99], v[98:99], v[16:17], v[70:71] op_sel_hi:[1,0,1]
    v_pk_fma_f32 v[124:125], v[124:125], v[18:19], v[208:209] op_sel_hi:[1,0,1]
    v_max_f32 v98, 0, v98
    v_max_f32 v99, 0, v99
    v_max_f32 v124, 0, v124
    v_max_f32 v125, 0, v125
    v_pk_mul_f32 v[98:99], v[98:99], v[98:99]
    v_pk_mul_f32 v[124:125], v[124:125], v[124:125]
    v_cvt_pk_bf16_f32 v153, v98, v99
    v_permlane32_swap_b32 v152, v154
    s_nop 0
    v_permlane32_swap_b32 v153, v155
    s_mov_b32 exec_hi, 0
    buffer_store_dwordx4 v[152:155], v2, s[48:51], s69 offen sc1
    s_mov_b64 exec, -1
    v_cvt_pk_bf16_f32 v248, v124, v125
    v_pk_fma_f32 v[126:127], v[126:127], v[18:19], v[210:211] op_sel_hi:[1,0,1]
    v_max_f32 v126, 0, v126
    v_max_f32_e64 v127, 0, v127
    v_pk_mul_f32 v[126:127], v[126:127], v[126:127]
    v_cvt_pk_bf16_f32 v249, v126, v127
    v_permlane32_swap_b32 v248, v250
    s_nop 0
    v_permlane32_swap_b32 v249, v251
    s_mov_b32 exec_hi, 0
    buffer_store_dwordx4 v[248:251], v2, s[48:51], s72 offen sc1
    s_mov_b64 exec, -1
    s_mul_i32 s12, s3, 14336
    s_mul_i32 s11, s6, 229376
    s_add_u32 s12, s12, s11
    s_add_u32 s12, s12, 9306112
    s_add_u32 s10, s3, 1
    s_and_b32 s10, s10, 3
    s_mul_i32 s11, s10, 57344
    s_add_u32 s64, s11, s12
    s_mul_i32 s10, s10, 15360
    s_add_u32 s10, s10, 0
    v_add_u32 v11, s10, v2
    buffer_load_dwordx4 a[88:91], v2, s[48:51], s25 offen offset:1024 sc1
    s_add_u32 s10, s3, 2
    s_and_b32 s10, s10, 3
    s_mul_i32 s11, s10, 57344
    s_add_u32 s65, s11, s12
    s_mul_i32 s10, s10, 15360
    s_add_u32 s10, s10, 5120
    v_add_u32 v12, s10, v2
    buffer_load_dwordx4 a[92:95], v2, s[48:51], s25 offen offset:2048 sc1
    s_add_u32 s10, s3, 3
    s_and_b32 s10, s10, 3
    s_mul_i32 s11, s10, 57344
    s_add_u32 s66, s11, s12
    s_mul_i32 s10, s10, 15360
    s_add_u32 s10, s10, 10240
    v_add_u32 v13, s10, v2
    s_add_u32 s10, s3, 4
    s_and_b32 s10, s10, 3
    s_mul_i32 s11, s10, 57344
    s_add_u32 s67, s11, s12
    s_mul_i32 s10, s10, 15360
    s_add_u32 s10, s10, 0
    v_add_u32 v14, s10, v2
    buffer_load_dwordx4 a[96:99], v2, s[48:51], s25 offen offset:3072 sc1
    s_add_u32 s25, s25, 4096
    s_mov_b32 s56, s34
    s_mov_b32 s57, s35
    s_mov_b32 s58, 2621440
    s_mov_b32 s59, 0x20000
    s_mul_i32 s10, s3, 2816
    s_add_u32 s10, s10, 65536
    v_lshrrev_b32 v7, 4, v1
    v_mul_u32_u24 v7, 40, v7
    v_and_b32_e64 v8, 15, v1
    v_mul_u32_u24 v8, 176, v8
    buffer_load_dwordx4 a[100:103], v2, s[48:51], s25 offen offset:0 sc1
    v_add3_u32 v15, v7, v8, s10
    v_add_u32_e64 v7, 0, v1
    v_mul_u32_u24 v8, 205, v7
    v_lshrrev_b32 v8, 11, v8
    v_lshlrev_b32 v7, 4, v7
    v_lshl_add_u32 v9, v8, 4, v7
    v_add_u32 v16, s10, v9
    buffer_load_dwordx4 a[136:139], v2, s[48:51], s25 offen offset:1024 sc1
    v_mul_u32_u24 v8, 1120, v8
    v_add_u32 v19, v7, v8
    v_add_u32_e64 v7, 64, v1
    v_mul_u32_u24 v8, 205, v7
    v_lshrrev_b32 v8, 11, v8
    v_lshlrev_b32 v7, 4, v7
    v_lshl_add_u32 v9, v8, 4, v7
    v_add_u32_e64 v17, s10, v9
    v_mul_u32_u24 v8, 1120, v8
    v_add_u32_e64 v20, v7, v8
    v_add_u32 v7, 128, v1
    v_mul_u32_u24 v8, 205, v7
    v_lshrrev_b32 v8, 11, v8
    v_lshlrev_b32 v7, 4, v7
    v_lshl_add_u32 v9, v8, 4, v7
    v_add_u32_e64 v18, s10, v9
    v_mul_u32_u24 v8, 1120, v8
    v_add_u32 v21, v7, v8
    v_mov_b32 v9, 1073741824
    v_cmp_gt_u32 vcc, 32, v1
    s_nop 1
    v_cndmask_b32 v21, v9, v21, vcc
    s_lshl_b32 s69, s6, 2
    s_add_u32 s69, s69, s3
    s_mul_i32 s69, s69, 20480
    s_mul_i32 s10, s7, 160
    s_add_u32 s69, s69, s10
    s_waitcnt vmcnt(5)
    s_barrier
    s_cmp_lg_u32 s3, 0
    s_cbranch_scc1 L_sig_90
    s_mov_b64 exec, 1
    s_add_u32 s10, s8, 96
    s_lshl_b32 s10, s10, 8
    buffer_atomic_add v4, v5, s[48:51], s10 offen sc1
    s_mov_b64 exec, -1
L_sig_90:
    buffer_load_dwordx4 a[140:143], v2, s[48:51], s25 offen offset:2048 sc1
    buffer_load_dwordx4 a[156:159], v2, s[48:51], s25 offen offset:3072 sc1
    s_add_u32 s25, s25, 4096
    buffer_load_dwordx4 a[160:163], v2, s[48:51], s25 offen offset:0 sc1
    buffer_load_dwordx4 a[192:195], v2, s[48:51], s25 offen offset:1024 sc1
    s_cmp_lg_u32 s3, 0
    s_cbranch_scc1 L_pi_92
    s_add_u32 s68, s1, 96
    s_lshl_b32 s68, s68, 8
    s_mov_b64 exec, 1
    v_mov_b32 v6, 0
    buffer_atomic_add v6, v5, s[48:51], s68 offen sc0 sc1
    s_mov_b64 exec, -1
L_pi_92:
    buffer_load_dwordx4 a[196:199], v2, s[48:51], s25 offen offset:2048 sc1
    buffer_load_dwordx4 a[200:203], v2, s[48:51], s25 offen offset:3072 sc1
    s_add_u32 s25, s25, 4096
    buffer_load_dwordx4 a[204:207], v2, s[48:51], s25 offen offset:0 sc1
    buffer_load_dwordx4 a[208:211], v2, s[48:51], s25 offen offset:1024 sc1
    buffer_load_dwordx4 a[212:215], v2, s[48:51], s25 offen offset:2048 sc1
    buffer_load_dwordx4 a[252:255], v2, s[48:51], s25 offen offset:3072 sc1
    s_add_u32 s25, s25, 4096
    buffer_load_dwordx4 v[252:255], v2, s[48:51], s25 offen offset:0 sc1
    buffer_load_dwordx4 v[248:251], v2, s[48:51], s25 offen offset:1024 sc1
    buffer_load_dwordx4 v[244:247], v2, s[48:51], s25 offen offset:2048 sc1
    buffer_load_dwordx4 v[240:243], v2, s[48:51], s25 offen offset:3072 sc1
    s_add_u32 s25, s25, 4096
    buffer_load_dwordx4 v[236:239], v2, s[48:51], s25 offen offset:0 sc1
    buffer_load_dwordx4 v[232:235], v2, s[48:51], s25 offen offset:1024 sc1
    s_cmp_lg_u32 s3, 0
    s_cbranch_scc1 L_ok_94
    s_mov_b64 exec, 1
    s_waitcnt vmcnt(12)
    v_cmp_gt_u32 vcc, 16, v6
    s_cbranch_vccz L_pd_97
    s_mov_b32 s70, 0
L_spin_95:
    v_mov_b32 v6, 0
    buffer_atomic_add v6, v5, s[48:51], s68 offen sc0 sc1
    s_add_u32 s70, s70, 1
    s_waitcnt vmcnt(0)
    v_cmp_gt_u32 vcc, 16, v6
    s_cmp_lt_u32 s70, 65536
    s_cselect_b64 vcc, vcc, 0
    s_cbranch_vccnz L_spin_95
L_pd_97:
    s_mov_b64 exec, -1
L_ok_94:
    s_barrier
    buffer_load_dwordx4 v[228:231], v2, s[48:51], s64 offen offset:0 sc1
    s_barrier
    buffer_load_dwordx4 v[224:227], v2, s[48:51], s64 offen offset:1024 sc1
    s_barrier
    buffer_load_dwordx4 v[220:223], v2, s[48:51], s64 offen offset:2048 sc1
    s_barrier
    buffer_load_dwordx4 v[216:219], v2, s[48:51], s64 offen offset:3072 sc1
    s_add_u32 s64, s64, 4096
    s_barrier
    buffer_load_dwordx4 v[212:215], v2, s[48:51], s64 offen offset:0 sc1
    s_barrier
    buffer_load_dwordx4 v[208:211], v2, s[48:51], s64 offen offset:1024 sc1
    s_barrier
    buffer_load_dwordx4 v[204:207], v2, s[48:51], s64 offen offset:2048 sc1
    s_barrier
    buffer_load_dwordx4 v[200:203], v2, s[48:51], s64 offen offset:3072 sc1
    s_add_u32 s64, s64, 4096
    s_barrier
    buffer_load_dwordx4 v[196:199], v2, s[48:51], s64 offen offset:0 sc1
    s_waitcnt vmcnt(8)
    v_mfma_f32_16x16x32_bf16 v[136:139], a[0:3], v[228:231], 0
    buffer_load_dwordx4 v[192:195], v2, s[48:51], s64 offen offset:1024 sc1
    v_mfma_f32_16x16x32_bf16 v[140:143], a[4:7], v[228:231], 0
    v_mfma_f32_16x16x32_bf16 v[144:147], a[8:11], v[228:231], 0
    v_mfma_f32_16x16x32_bf16 v[148:151], a[12:15], v[228:231], 0
    v_mfma_f32_16x16x32_bf16 v[152:155], a[16:19], v[228:231], 0
    s_waitcnt vmcnt(8)
    v_mfma_f32_16x16x32_bf16 v[136:139], a[20:23], v[224:227], v[136:139]
    buffer_load_dwordx4 v[188:191], v2, s[48:51], s64 offen offset:2048 sc1
    v_mfma_f32_16x16x32_bf16 v[140:143], a[104:107], v[224:227], v[140:143]
    v_mfma_f32_16x16x32_bf16 v[144:147], a[108:111], v[224:227], v[144:147]
    v_mfma_f32_16x16x32_bf16 v[148:151], a[112:115], v[224:227], v[148:151]
    v_mfma_f32_16x16x32_bf16 v[152:155], a[116:119], v[224:227], v[152:155]
    s_waitcnt vmcnt(8)
    v_mfma_f32_16x16x32_bf16 v[136:139], a[120:123], v[220:223], v[136:139]
    buffer_load_dwordx4 v[228:231], v2, s[48:51], s64 offen offset:3072 sc1
    v_mfma_f32_16x16x32_bf16 v[140:143], a[124:127], v[220:223], v[140:143]
    s_add_u32 s64, s64, 4096
    v_mfma_f32_16x16x32_bf16 v[144:147], a[128:131], v[220:223], v[144:147]
    v_mfma_f32_16x16x32_bf16 v[148:151], a[132:135], v[220:223], v[148:151]
    v_mfma_f32_16x16x32_bf16 v[152:155], a[24:27], v[220:223], v[152:155]
    s_waitcnt vmcnt(8)
    v_mfma_f32_16x16x32_bf16 v[136:139], a[28:31], v[216:219], v[136:139]
    buffer_load_dwordx4 v[224:227], v2, s[48:51], s64 offen offset:0 sc1
    v_mfma_f32_16x16x32_bf16 v[140:143], a[32:35], v[216:219], v[140:143]
    v_mfma_f32_16x16x32_bf16 v[144:147], a[36:39], v[216:219], v[144:147]
    v_mfma_f32_16x16x32_bf16 v[148:151], a[40:43], v[216:219], v[148:151]
    v_mfma_f32_16x16x32_bf16 v[152:155], a[44:47], v[216:219], v[152:155]
    s_waitcnt vmcnt(8)
    v_mfma_f32_16x16x32_bf16 v[136:139], a[48:51], v[212:215], v[136:139]
    buffer_load_dwordx4 v[220:223], v2, s[48:51], s64 offen offset:1024 sc1
    v_mfma_f32_16x16x32_bf16 v[140:143], a[52:55], v[212:215], v[140:143]
    v_mfma_f32_16x16x32_bf16 v[144:147], a[56:59], v[212:215], v[144:147]
    v_mfma_f32_16x16x32_bf16 v[148:151], a[60:63], v[212:215], v[148:151]
    v_mfma_f32_16x16x32_bf16 v[152:155], a[64:67], v[212:215], v[152:155]
    s_waitcnt vmcnt(8)
    v_mfma_f32_16x16x32_bf16 v[136:139], a[68:71], v[208:211], v[136:139]
    buffer_load_dwordx4 v[216:219], v2, s[48:51], s65 offen offset:0 sc1
    v_mfma_f32_16x16x32_bf16 v[140:143], a[72:75], v[208:211], v[140:143]
    v_mfma_f32_16x16x32_bf16 v[144:147], a[76:79], v[208:211], v[144:147]
    v_mfma_f32_16x16x32_bf16 v[148:151], a[80:83], v[208:211], v[148:151]
    v_mfma_f32_16x16x32_bf16 v[152:155], a[164:167], v[208:211], v[152:155]
    s_waitcnt vmcnt(8)
    v_mfma_f32_16x16x32_bf16 v[136:139], a[168:171], v[204:207], v[136:139]
    buffer_load_dwordx4 v[212:215], v2, s[48:51], s65 offen offset:1024 sc1
    v_mfma_f32_16x16x32_bf16 v[140:143], a[172:175], v[204:207], v[140:143]
    v_mfma_f32_16x16x32_bf16 v[144:147], a[176:179], v[204:207], v[144:147]
    v_mfma_f32_16x16x32_bf16 v[148:151], a[144:147], v[204:207], v[148:151]
    v_mfma_f32_16x16x32_bf16 v[152:155], a[216:219], v[204:207], v[152:155]
    s_waitcnt vmcnt(8)
    v_mfma_f32_16x16x32_bf16 v[136:139], a[180:183], v[200:203], v[136:139]
    buffer_load_dwordx4 v[208:211], v2, s[48:51], s65 offen offset:2048 sc1
    v_mfma_f32_16x16x32_bf16 v[140:143], a[148:151], v[200:203], v[140:143]
    v_mfma_f32_16x16x32_bf16 v[144:147], a[220:223], v[200:203], v[144:147]
    v_mfma_f32_16x16x32_bf16 v[148:151], a[224:227], v[200:203], v[148:151]
    v_mfma_f32_16x16x32_bf16 v[152:155], a[152:155], v[200:203], v[152:155]
    s_waitcnt vmcnt(8)
    v_mfma_f32_16x16x32_bf16 v[136:139], a[184:187], v[196:199], v[136:139]
    buffer_load_dwordx4 v[204:207], v2, s[48:51], s65 offen offset:3072 sc1
    v_mfma_f32_16x16x32_bf16 v[140:143], a[228:231], v[196:199], v[140:143]
    s_add_u32 s65, s65, 4096
    v_mfma_f32_16x16x32_bf16 v[144:147], a[188:191], v[196:199], v[144:147]
    v_mfma_f32_16x16x32_bf16 v[148:151], a[84:87], v[196:199], v[148:151]
    v_mfma_f32_16x16x32_bf16 v[152:155], a[232:235], v[196:199], v[152:155]
    s_waitcnt vmcnt(8)
    v_mfma_f32_16x16x32_bf16 v[136:139], a[236:239], v[192:195], v[136:139]
    buffer_load_dwordx4 v[200:203], v2, s[48:51], s65 offen offset:0 sc1
    v_mfma_f32_16x16x32_bf16 v[140:143], a[240:243], v[192:195], v[140:143]
    v_mfma_f32_16x16x32_bf16 v[144:147], a[244:247], v[192:195], v[144:147]
    v_mfma_f32_16x16x32_bf16 v[148:151], a[248:251], v[192:195], v[148:151]
    v_mfma_f32_16x16x32_bf16 v[152:155], a[88:91], v[192:195], v[152:155]
    s_waitcnt vmcnt(8)
    v_mfma_f32_16x16x32_bf16 v[136:139], a[92:95], v[188:191], v[136:139]
    buffer_load_dwordx4 v[196:199], v2, s[48:51], s65 offen offset:1024 sc1
    v_mfma_f32_16x16x32_bf16 v[140:143], a[96:99], v[188:191], v[140:143]
    v_mfma_f32_16x16x32_bf16 v[144:147], a[100:103], v[188:191], v[144:147]
    v_mfma_f32_16x16x32_bf16 v[148:151], a[136:139], v[188:191], v[148:151]
    v_mfma_f32_16x16x32_bf16 v[152:155], a[140:143], v[188:191], v[152:155]
    s_waitcnt vmcnt(8)
    v_mfma_f32_16x16x32_bf16 v[136:139], a[156:159], v[228:231], v[136:139]
    buffer_load_dwordx4 v[192:195], v2, s[48:51], s65 offen offset:2048 sc1
    v_mfma_f32_16x16x32_bf16 v[140:143], a[160:163], v[228:231], v[140:143]
    v_mfma_f32_16x16x32_bf16 v[144:147], a[192:195], v[228:231], v[144:147]
    v_mfma_f32_16x16x32_bf16 v[148:151], a[196:199], v[228:231], v[148:151]
    v_mfma_f32_16x16x32_bf16 v[152:155], a[200:203], v[228:231], v[152:155]
    s_waitcnt vmcnt(8)
    v_mfma_f32_16x16x32_bf16 v[136:139], a[204:207], v[224:227], v[136:139]
    buffer_load_dwordx4 v[188:191], v2, s[48:51], s65 offen offset:3072 sc1
    v_mfma_f32_16x16x32_bf16 v[140:143], a[208:211], v[224:227], v[140:143]
    s_add_u32 s65, s65, 4096
    v_mfma_f32_16x16x32_bf16 v[144:147], a[212:215], v[224:227], v[144:147]
    v_mfma_f32_16x16x32_bf16 v[148:151], a[252:255], v[224:227], v[148:151]
    v_mfma_f32_16x16x32_bf16 v[152:155], v[252:255], v[224:227], v[152:155]
    s_waitcnt vmcnt(8)
    v_mfma_f32_16x16x32_bf16 v[136:139], v[248:251], v[220:223], v[136:139]
    buffer_load_dwordx4 v[228:231], v2, s[48:51], s65 offen offset:0 sc1
    v_mfma_f32_16x16x32_bf16 v[140:143], v[244:247], v[220:223], v[140:143]
    v_mfma_f32_16x16x32_bf16 v[144:147], v[240:243], v[220:223], v[144:147]
    v_mfma_f32_16x16x32_bf16 v[148:151], v[236:239], v[220:223], v[148:151]
    v_mfma_f32_16x16x32_bf16 v[152:155], v[232:235], v[220:223], v[152:155]
    s_waitcnt vmcnt(8)
    v_mfma_f32_16x16x32_bf16 v[116:119], a[0:3], v[216:219], 0
    buffer_load_dwordx4 v[224:227], v2, s[48:51], s65 offen offset:1024 sc1
    v_mfma_f32_16x16x32_bf16 v[120:123], a[4:7], v[216:219], 0
    ds_write_b128 v11, v[136:139] offset:0
    v_mfma_f32_16x16x32_bf16 v[124:127], a[8:11], v[216:219], 0
    v_mfma_f32_16x16x32_bf16 v[128:131], a[12:15], v[216:219], 0
    v_mfma_f32_16x16x32_bf16 v[132:135], a[16:19], v[216:219], 0
    s_waitcnt vmcnt(8)
    v_mfma_f32_16x16x32_bf16 v[116:119], a[20:23], v[212:215], v[116:119]
    buffer_load_dwordx4 v[220:223], v2, s[48:51], s65 offen offset:2048 sc1
    v_mfma_f32_16x16x32_bf16 v[120:123], a[104:107], v[212:215], v[120:123]
    ds_write_b128 v11, v[140:143] offset:1024
    v_mfma_f32_16x16x32_bf16 v[124:127], a[108:111], v[212:215], v[124:127]
    v_mfma_f32_16x16x32_bf16 v[128:131], a[112:115], v[212:215], v[128:131]
    v_mfma_f32_16x16x32_bf16 v[132:135], a[116:119], v[212:215], v[132:135]
    s_waitcnt vmcnt(8)
    v_mfma_f32_16x16x32_bf16 v[116:119], a[120:123], v[208:211], v[116:119]
    buffer_load_dwordx4 v[216:219], v2, s[48:51], s65 offen offset:3072 sc1
    v_mfma_f32_16x16x32_bf16 v[120:123], a[124:127], v[208:211], v[120:123]
    s_add_u32 s65, s65, 4096
    v_mfma_f32_16x16x32_bf16 v[124:127], a[128:131], v[208:211], v[124:127]
    ds_write_b128 v11, v[144:147] offset:2048
    v_mfma_f32_16x16x32_bf16 v[128:131], a[132:135], v[208:211], v[128:131]
    v_mfma_f32_16x16x32_bf16 v[132:135], a[24:27], v[208:211], v[132:135]
    s_waitcnt vmcnt(8)
    v_mfma_f32_16x16x32_bf16 v[116:119], a[28:31], v[204:207], v[116:119]
    buffer_load_dwordx4 v[212:215], v2, s[48:51], s65 offen offset:0 sc1
    v_mfma_f32_16x16x32_bf16 v[120:123], a[32:35], v[204:207], v[120:123]
    ds_write_b128 v11, v[148:151] offset:3072
    v_mfma_f32_16x16x32_bf16 v[124:127], a[36:39], v[204:207], v[124:127]
    v_mfma_f32_16x16x32_bf16 v[128:131], a[40:43], v[204:207], v[128:131]
    v_mfma_f32_16x16x32_bf16 v[132:135], a[44:47], v[204:207], v[132:135]
    s_waitcnt vmcnt(8)
    v_mfma_f32_16x16x32_bf16 v[116:119], a[48:51], v[200:203], v[116:119]
    buffer_load_dwordx4 v[208:211], v2, s[48:51], s65 offen offset:1024 sc1
    v_mfma_f32_16x16x32_bf16 v[120:123], a[52:55], v[200:203], v[120:123]
    ds_write_b128 v11, v[152:155] offset:4096
    v_mfma_f32_16x16x32_bf16 v[124:127], a[56:59], v[200:203], v[124:127]
    v_mfma_f32_16x16x32_bf16 v[128:131], a[60:63], v[200:203], v[128:131]
    v_mfma_f32_16x16x32_bf16 v[132:135], a[64:67], v[200:203], v[132:135]
    s_waitcnt vmcnt(8)
    v_mfma_f32_16x16x32_bf16 v[116:119], a[68:71], v[196:199], v[116:119]
    buffer_load_dwordx4 v[204:207], v2, s[48:51], s66 offen offset:0 sc1
    v_mfma_f32_16x16x32_bf16 v[120:123], a[72:75], v[196:199], v[120:123]
    v_mfma_f32_16x16x32_bf16 v[124:127], a[76:79], v[196:199], v[124:127]
    v_mfma_f32_16x16x32_bf16 v[128:131], a[80:83], v[196:199], v[128:131]
    v_mfma_f32_16x16x32_bf16 v[132:135], a[164:167], v[196:199], v[132:135]
    s_waitcnt vmcnt(8)
    v_mfma_f32_16x16x32_bf16 v[116:119], a[168:171], v[192:195], v[116:119]
    buffer_load_dwordx4 v[200:203], v2, s[48:51], s66 offen offset:1024 sc1
    v_mfma_f32_16x16x32_bf16 v[120:123], a[172:175], v[192:195], v[120:123]
    v_mfma_f32_16x16x32_bf16 v[124:127], a[176:179], v[192:195], v[124:127]
    v_mfma_f32_16x16x32_bf16 v[128:131], a[144:147], v[192:195], v[128:131]
    v_mfma_f32_16x16x32_bf16 v[132:135], a[216:219], v[192:195], v[132:135]
    s_waitcnt vmcnt(8)
    v_mfma_f32_16x16x32_bf16 v[116:119], a[180:183], v[188:191], v[116:119]
    buffer_load_dwordx4 v[196:199], v2, s[48:51], s66 offen offset:2048 sc1
    v_mfma_f32_16x16x32_bf16 v[120:123], a[148:151], v[188:191], v[120:123]
    v_mfma_f32_16x16x32_bf16 v[124:127], a[220:223], v[188:191], v[124:127]
    v_mfma_f32_16x16x32_bf16 v[128:131], a[224:227], v[188:191], v[128:131]
    v_mfma_f32_16x16x32_bf16 v[132:135], a[152:155], v[188:191], v[132:135]
    s_waitcnt vmcnt(8)
    v_mfma_f32_16x16x32_bf16 v[116:119], a[184:187], v[228:231], v[116:119]
    buffer_load_dwordx4 v[192:195], v2, s[48:51], s66 offen offset:3072 sc1
    v_mfma_f32_16x16x32_bf16 v[120:123], a[228:231], v[228:231], v[120:123]
    s_add_u32 s66, s66, 4096
    v_mfma_f32_16x16x32_bf16 v[124:127], a[188:191], v[228:231], v[124:127]
    v_mfma_f32_16x16x32_bf16 v[128:131], a[84:87], v[228:231], v[128:131]
    v_mfma_f32_16x16x32_bf16 v[132:135], a[232:235], v[228:231], v[132:135]
    s_waitcnt vmcnt(8)
    v_mfma_f32_16x16x32_bf16 v[116:119], a[236:239], v[224:227], v[116:119]
    buffer_load_dwordx4 v[188:191], v2, s[48:51], s66 offen offset:0 sc1
    v_mfma_f32_16x16x32_bf16 v[120:123], a[240:243], v[224:227], v[120:123]
    v_mfma_f32_16x16x32_bf16 v[124:127], a[244:247], v[224:227], v[124:127]
    v_mfma_f32_16x16x32_bf16 v[128:131], a[248:251], v[224:227], v[128:131]
    v_mfma_f32_16x16x32_bf16 v[132:135], a[88:91], v[224:227], v[132:135]
    s_waitcnt vmcnt(8)
    v_mfma_f32_16x16x32_bf16 v[116:119], a[92:95], v[220:223], v[116:119]
    buffer_load_dwordx4 v[228:231], v2, s[48:51], s66 offen offset:1024 sc1
    v_mfma_f32_16x16x32_bf16 v[120:123], a[96:99], v[220:223], v[120:123]
    v_mfma_f32_16x16x32_bf16 v[124:127], a[100:103], v[220:223], v[124:127]
    v_mfma_f32_16x16x32_bf16 v[128:131], a[136:139], v[220:223], v[128:131]
    v_mfma_f32_16x16x32_bf16 v[132:135], a[140:143], v[220:223], v[132:135]
    s_waitcnt vmcnt(8)
    v_mfma_f32_16x16x32_bf16 v[116:119], a[156:159], v[216:219], v[116:119]
    buffer_load_dwordx4 v[224:227], v2, s[48:51], s66 offen offset:2048 sc1
    v_mfma_f32_16x16x32_bf16 v[120:123], a[160:163], v[216:219], v[120:123]
    v_mfma_f32_16x16x32_bf16 v[124:127], a[192:195], v[216:219], v[124:127]
    v_mfma_f32_16x16x32_bf16 v[128:131], a[196:199], v[216:219], v[128:131]
    v_mfma_f32_16x16x32_bf16 v[132:135], a[200:203], v[216:219], v[132:135]
    s_waitcnt vmcnt(8)
    v_mfma_f32_16x16x32_bf16 v[116:119], a[204:207], v[212:215], v[116:119]
    buffer_load_dwordx4 v[220:223], v2, s[48:51], s66 offen offset:3072 sc1
    v_mfma_f32_16x16x32_bf16 v[120:123], a[208:211], v[212:215], v[120:123]
    s_add_u32 s66, s66, 4096
    v_mfma_f32_16x16x32_bf16 v[124:127], a[212:215], v[212:215], v[124:127]
    v_mfma_f32_16x16x32_bf16 v[128:131], a[252:255], v[212:215], v[128:131]
    v_mfma_f32_16x16x32_bf16 v[132:135], v[252:255], v[212:215], v[132:135]
    s_waitcnt vmcnt(8)
    v_mfma_f32_16x16x32_bf16 v[116:119], v[248:251], v[208:211], v[116:119]
    buffer_load_dwordx4 v[216:219], v2, s[48:51], s66 offen offset:0 sc1
    v_mfma_f32_16x16x32_bf16 v[120:123], v[244:247], v[208:211], v[120:123]
    v_mfma_f32_16x16x32_bf16 v[124:127], v[240:243], v[208:211], v[124:127]
    v_mfma_f32_16x16x32_bf16 v[128:131], v[236:239], v[208:211], v[128:131]
    v_mfma_f32_16x16x32_bf16 v[132:135], v[232:235], v[208:211], v[132:135]
    s_waitcnt vmcnt(8)
    v_mfma_f32_16x16x32_bf16 v[96:99], a[0:3], v[204:207], 0
    buffer_load_dwordx4 v[212:215], v2, s[48:51], s66 offen offset:1024 sc1
    v_mfma_f32_16x16x32_bf16 v[100:103], a[4:7], v[204:207], 0
    ds_write_b128 v12, v[116:119] offset:0
    v_mfma_f32_16x16x32_bf16 v[104:107], a[8:11], v[204:207], 0
    v_mfma_f32_16x16x32_bf16 v[108:111], a[12:15], v[204:207], 0
    v_mfma_f32_16x16x32_bf16 v[112:115], a[16:19], v[204:207], 0
    s_waitcnt vmcnt(8)
    v_mfma_f32_16x16x32_bf16 v[96:99], a[20:23], v[200:203], v[96:99]
    buffer_load_dwordx4 v[208:211], v2, s[48:51], s66 offen offset:2048 sc1
    v_mfma_f32_16x16x32_bf16 v[100:103], a[104:107], v[200:203], v[100:103]
    ds_write_b128 v12, v[120:123] offset:1024
    v_mfma_f32_16x16x32_bf16 v[104:107], a[108:111], v[200:203], v[104:107]
    v_mfma_f32_16x16x32_bf16 v[108:111], a[112:115], v[200:203], v[108:111]
    v_mfma_f32_16x16x32_bf16 v[112:115], a[116:119], v[200:203], v[112:115]
    s_waitcnt vmcnt(8)
    v_mfma_f32_16x16x32_bf16 v[96:99], a[120:123], v[196:199], v[96:99]
    buffer_load_dwordx4 v[204:207], v2, s[48:51], s66 offen offset:3072 sc1
    v_mfma_f32_16x16x32_bf16 v[100:103], a[124:127], v[196:199], v[100:103]
    s_add_u32 s66, s66, 4096
    v_mfma_f32_16x16x32_bf16 v[104:107], a[128:131], v[196:199], v[104:107]
    ds_write_b128 v12, v[124:127] offset:2048
    v_mfma_f32_16x16x32_bf16 v[108:111], a[132:135], v[196:199], v[108:111]
    v_mfma_f32_16x16x32_bf16 v[112:115], a[24:27], v[196:199], v[112:115]
    s_waitcnt vmcnt(8)
    v_mfma_f32_16x16x32_bf16 v[96:99], a[28:31], v[192:195], v[96:99]
    buffer_load_dwordx4 v[200:203], v2, s[48:51], s66 offen offset:0 sc1
    v_mfma_f32_16x16x32_bf16 v[100:103], a[32:35], v[192:195], v[100:103]
    ds_write_b128 v12, v[128:131] offset:3072
    v_mfma_f32_16x16x32_bf16 v[104:107], a[36:39], v[192:195], v[104:107]
    v_mfma_f32_16x16x32_bf16 v[108:111], a[40:43], v[192:195], v[108:111]
    v_mfma_f32_16x16x32_bf16 v[112:115], a[44:47], v[192:195], v[112:115]
    s_waitcnt vmcnt(8)
    v_mfma_f32_16x16x32_bf16 v[96:99], a[48:51], v[188:191], v[96:99]
    buffer_load_dwordx4 v[196:199], v2, s[48:51], s66 offen offset:1024 sc1
    v_mfma_f32_16x16x32_bf16 v[100:103], a[52:55], v[188:191], v[100:103]
    ds_write_b128 v12, v[132:135] offset:4096
    v_mfma_f32_16x16x32_bf16 v[104:107], a[56:59], v[188:191], v[104:107]
    v_mfma_f32_16x16x32_bf16 v[108:111], a[60:63], v[188:191], v[108:111]
    v_mfma_f32_16x16x32_bf16 v[112:115], a[64:67], v[188:191], v[112:115]
    s_waitcnt vmcnt(8)
    v_mfma_f32_16x16x32_bf16 v[96:99], a[68:71], v[228:231], v[96:99]
    buffer_load_dwordx4 v[192:195], v2, s[48:51], s67 offen offset:0 sc1
    v_mfma_f32_16x16x32_bf16 v[100:103], a[72:75], v[228:231], v[100:103]
    v_mfma_f32_16x16x32_bf16 v[104:107], a[76:79], v[228:231], v[104:107]
    v_mfma_f32_16x16x32_bf16 v[108:111], a[80:83], v[228:231], v[108:111]
    v_mfma_f32_16x16x32_bf16 v[112:115], a[164:167], v[228:231], v[112:115]
    s_waitcnt vmcnt(8)
    v_mfma_f32_16x16x32_bf16 v[96:99], a[168:171], v[224:227], v[96:99]
    buffer_load_dwordx4 v[188:191], v2, s[48:51], s67 offen offset:1024 sc1
    v_mfma_f32_16x16x32_bf16 v[100:103], a[172:175], v[224:227], v[100:103]
    v_mfma_f32_16x16x32_bf16 v[104:107], a[176:179], v[224:227], v[104:107]
    v_mfma_f32_16x16x32_bf16 v[108:111], a[144:147], v[224:227], v[108:111]
    v_mfma_f32_16x16x32_bf16 v[112:115], a[216:219], v[224:227], v[112:115]
    s_waitcnt vmcnt(8)
    v_mfma_f32_16x16x32_bf16 v[96:99], a[180:183], v[220:223], v[96:99]
    buffer_load_dwordx4 v[228:231], v2, s[48:51], s67 offen offset:2048 sc1
    v_mfma_f32_16x16x32_bf16 v[100:103], a[148:151], v[220:223], v[100:103]
    v_mfma_f32_16x16x32_bf16 v[104:107], a[220:223], v[220:223], v[104:107]
    v_mfma_f32_16x16x32_bf16 v[108:111], a[224:227], v[220:223], v[108:111]
    v_mfma_f32_16x16x32_bf16 v[112:115], a[152:155], v[220:223], v[112:115]
    s_waitcnt vmcnt(8)
    v_mfma_f32_16x16x32_bf16 v[96:99], a[184:187], v[216:219], v[96:99]
    buffer_load_dwordx4 v[224:227], v2, s[48:51], s67 offen offset:3072 sc1
    v_mfma_f32_16x16x32_bf16 v[100:103], a[228:231], v[216:219], v[100:103]
    s_add_u32 s67, s67, 4096
    v_mfma_f32_16x16x32_bf16 v[104:107], a[188:191], v[216:219], v[104:107]
    v_mfma_f32_16x16x32_bf16 v[108:111], a[84:87], v[216:219], v[108:111]
    v_mfma_f32_16x16x32_bf16 v[112:115], a[232:235], v[216:219], v[112:115]
    s_waitcnt vmcnt(8)
    v_mfma_f32_16x16x32_bf16 v[96:99], a[236:239], v[212:215], v[96:99]
    buffer_load_dwordx4 v[220:223], v2, s[48:51], s67 offen offset:0 sc1
    v_mfma_f32_16x16x32_bf16 v[100:103], a[240:243], v[212:215], v[100:103]
    v_mfma_f32_16x16x32_bf16 v[104:107], a[244:247], v[212:215], v[104:107]
    v_mfma_f32_16x16x32_bf16 v[108:111], a[248:251], v[212:215], v[108:111]
    v_mfma_f32_16x16x32_bf16 v[112:115], a[88:91], v[212:215], v[112:115]
    s_waitcnt vmcnt(8)
    v_mfma_f32_16x16x32_bf16 v[96:99], a[92:95], v[208:211], v[96:99]
    buffer_load_dwordx4 v[216:219], v2, s[48:51], s67 offen offset:1024 sc1
    v_mfma_f32_16x16x32_bf16 v[100:103], a[96:99], v[208:211], v[100:103]
    v_mfma_f32_16x16x32_bf16 v[104:107], a[100:103], v[208:211], v[104:107]
    v_mfma_f32_16x16x32_bf16 v[108:111], a[136:139], v[208:211], v[108:111]
    v_mfma_f32_16x16x32_bf16 v[112:115], a[140:143], v[208:211], v[112:115]
    s_waitcnt vmcnt(8)
    v_mfma_f32_16x16x32_bf16 v[96:99], a[156:159], v[204:207], v[96:99]
    buffer_load_dwordx4 v[212:215], v2, s[48:51], s67 offen offset:2048 sc1
    v_mfma_f32_16x16x32_bf16 v[100:103], a[160:163], v[204:207], v[100:103]
    v_mfma_f32_16x16x32_bf16 v[104:107], a[192:195], v[204:207], v[104:107]
    v_mfma_f32_16x16x32_bf16 v[108:111], a[196:199], v[204:207], v[108:111]
    v_mfma_f32_16x16x32_bf16 v[112:115], a[200:203], v[204:207], v[112:115]
    s_waitcnt vmcnt(8)
    v_mfma_f32_16x16x32_bf16 v[96:99], a[204:207], v[200:203], v[96:99]
    buffer_load_dwordx4 v[208:211], v2, s[48:51], s67 offen offset:3072 sc1
    v_mfma_f32_16x16x32_bf16 v[100:103], a[208:211], v[200:203], v[100:103]
    s_add_u32 s67, s67, 4096
    v_mfma_f32_16x16x32_bf16 v[104:107], a[212:215], v[200:203], v[104:107]
    v_mfma_f32_16x16x32_bf16 v[108:111], a[252:255], v[200:203], v[108:111]
    v_mfma_f32_16x16x32_bf16 v[112:115], v[252:255], v[200:203], v[112:115]
    s_waitcnt vmcnt(8)
    v_mfma_f32_16x16x32_bf16 v[96:99], v[248:251], v[196:199], v[96:99]
    buffer_load_dwordx4 v[204:207], v2, s[48:51], s67 offen offset:0 sc1
    v_mfma_f32_16x16x32_bf16 v[100:103], v[244:247], v[196:199], v[100:103]
    v_mfma_f32_16x16x32_bf16 v[104:107], v[240:243], v[196:199], v[104:107]
    v_mfma_f32_16x16x32_bf16 v[108:111], v[236:239], v[196:199], v[108:111]
    v_mfma_f32_16x16x32_bf16 v[112:115], v[232:235], v[196:199], v[112:115]
    s_waitcnt vmcnt(8)
    v_mfma_f32_16x16x32_bf16 v[156:159], a[0:3], v[192:195], v[156:159]
    buffer_load_dwordx4 v[200:203], v2, s[48:51], s67 offen offset:1024 sc1
    v_mfma_f32_16x16x32_bf16 v[160:163], a[4:7], v[192:195], v[160:163]
    ds_write_b128 v13, v[96:99] offset:0
    v_mfma_f32_16x16x32_bf16 v[164:167], a[8:11], v[192:195], v[164:167]
    v_mfma_f32_16x16x32_bf16 v[168:171], a[12:15], v[192:195], v[168:171]
    v_mfma_f32_16x16x32_bf16 v[172:175], a[16:19], v[192:195], v[172:175]
    s_waitcnt vmcnt(8)
    v_mfma_f32_16x16x32_bf16 v[156:159], a[20:23], v[188:191], v[156:159]
    buffer_load_dwordx4 v[196:199], v2, s[48:51], s67 offen offset:2048 sc1
    v_mfma_f32_16x16x32_bf16 v[160:163], a[104:107], v[188:191], v[160:163]
    ds_write_b128 v13, v[100:103] offset:1024
    v_mfma_f32_16x16x32_bf16 v[164:167], a[108:111], v[188:191], v[164:167]
    v_mfma_f32_16x16x32_bf16 v[168:171], a[112:115], v[188:191], v[168:171]
    v_mfma_f32_16x16x32_bf16 v[172:175], a[116:119], v[188:191], v[172:175]
    s_waitcnt vmcnt(8)
    v_mfma_f32_16x16x32_bf16 v[156:159], a[120:123], v[228:231], v[156:159]
    buffer_load_dwordx4 v[192:195], v2, s[48:51], s67 offen offset:3072 sc1
    v_mfma_f32_16x16x32_bf16 v[160:163], a[124:127], v[228:231], v[160:163]
    s_add_u32 s67, s67, 4096
    v_mfma_f32_16x16x32_bf16 v[164:167], a[128:131], v[228:231], v[164:167]
    ds_write_b128 v13, v[104:107] offset:2048
    v_mfma_f32_16x16x32_bf16 v[168:171], a[132:135], v[228:231], v[168:171]
    v_mfma_f32_16x16x32_bf16 v[172:175], a[24:27], v[228:231], v[172:175]
    s_waitcnt vmcnt(8)
    v_mfma_f32_16x16x32_bf16 v[156:159], a[28:31], v[224:227], v[156:159]
    buffer_load_dwordx4 v[188:191], v2, s[48:51], s67 offen offset:0 sc1
    v_mfma_f32_16x16x32_bf16 v[160:163], a[32:35], v[224:227], v[160:163]
    ds_write_b128 v13, v[108:111] offset:3072
    v_mfma_f32_16x16x32_bf16 v[164:167], a[36:39], v[224:227], v[164:167]
    v_mfma_f32_16x16x32_bf16 v[168:171], a[40:43], v[224:227], v[168:171]
    v_mfma_f32_16x16x32_bf16 v[172:175], a[44:47], v[224:227], v[172:175]
    s_waitcnt vmcnt(8)
    v_mfma_f32_16x16x32_bf16 v[156:159], a[48:51], v[220:223], v[156:159]
    buffer_load_dwordx4 v[228:231], v2, s[48:51], s67 offen offset:1024 sc1
    v_mfma_f32_16x16x32_bf16 v[160:163], a[52:55], v[220:223], v[160:163]
    ds_write_b128 v13, v[112:115] offset:4096
    v_mfma_f32_16x16x32_bf16 v[164:167], a[56:59], v[220:223], v[164:167]
    v_mfma_f32_16x16x32_bf16 v[168:171], a[60:63], v[220:223], v[168:171]
    v_mfma_f32_16x16x32_bf16 v[172:175], a[64:67], v[220:223], v[172:175]
    s_waitcnt vmcnt(8)
    v_mfma_f32_16x16x32_bf16 v[156:159], a[68:71], v[216:219], v[156:159]
    v_mfma_f32_16x16x32_bf16 v[160:163], a[72:75], v[216:219], v[160:163]
    v_mfma_f32_16x16x32_bf16 v[164:167], a[76:79], v[216:219], v[164:167]
    v_mfma_f32_16x16x32_bf16 v[168:171], a[80:83], v[216:219], v[168:171]
    v_mfma_f32_16x16x32_bf16 v[172:175], a[164:167], v[216:219], v[172:175]
    s_waitcnt vmcnt(7)
    v_mfma_f32_16x16x32_bf16 v[156:159], a[168:171], v[212:215], v[156:159]
    v_mfma_f32_16x16x32_bf16 v[160:163], a[172:175], v[212:215], v[160:163]
    v_mfma_f32_16x16x32_bf16 v[164:167], a[176:179], v[212:215], v[164:167]
    v_mfma_f32_16x16x32_bf16 v[168:171], a[144:147], v[212:215], v[168:171]
    v_mfma_f32_16x16x32_bf16 v[172:175], a[216:219], v[212:215], v[172:175]
    s_waitcnt vmcnt(6)
    v_mfma_f32_16x16x32_bf16 v[156:159], a[180:183], v[208:211], v[156:159]
    s_waitcnt lgkmcnt(0)
    s_barrier
    v_mfma_f32_16x16x32_bf16 v[160:163], a[148:151], v[208:211], v[160:163]
    ds_read_b128 v[136:139], v14 offset:0
    ds_read_b128 v[140:143], v14 offset:1024
    v_mfma_f32_16x16x32_bf16 v[164:167], a[220:223], v[208:211], v[164:167]
    ds_read_b128 v[144:147], v14 offset:2048
    ds_read_b128 v[148:151], v14 offset:3072
    v_mfma_f32_16x16x32_bf16 v[168:171], a[224:227], v[208:211], v[168:171]
    ds_read_b128 v[152:155], v14 offset:4096
    ds_read_b128 v[116:119], v14 offset:5120
    v_mfma_f32_16x16x32_bf16 v[172:175], a[152:155], v[208:211], v[172:175]
    ds_read_b128 v[120:123], v14 offset:6144
    s_waitcnt vmcnt(5)
    v_mfma_f32_16x16x32_bf16 v[156:159], a[184:187], v[204:207], v[156:159]
    ds_read_b128 v[124:127], v14 offset:7168
    ds_read_b128 v[128:131], v14 offset:8192
    v_mfma_f32_16x16x32_bf16 v[160:163], a[228:231], v[204:207], v[160:163]
    ds_read_b128 v[132:135], v14 offset:9216
    ds_read_b128 v[96:99], v14 offset:10240
    v_mfma_f32_16x16x32_bf16 v[164:167], a[188:191], v[204:207], v[164:167]
    ds_read_b128 v[100:103], v14 offset:11264
    ds_read_b128 v[104:107], v14 offset:12288
    v_mfma_f32_16x16x32_bf16 v[168:171], a[84:87], v[204:207], v[168:171]
    ds_read_b128 v[108:111], v14 offset:13312
    ds_read_b128 v[112:115], v14 offset:14336
    v_mfma_f32_16x16x32_bf16 v[172:175], a[232:235], v[204:207], v[172:175]
    s_waitcnt vmcnt(4)
    v_mfma_f32_16x16x32_bf16 v[156:159], a[236:239], v[200:203], v[156:159]
    v_mfma_f32_16x16x32_bf16 v[160:163], a[240:243], v[200:203], v[160:163]
    s_waitcnt lgkmcnt(9)
    v_add_f32 v136, v136, v116
    v_add_f32 v137, v137, v117
    v_mfma_f32_16x16x32_bf16 v[164:167], a[244:247], v[200:203], v[164:167]
    v_add_f32 v138, v138, v118
    v_add_f32 v139, v139, v119
    v_mfma_f32_16x16x32_bf16 v[168:171], a[248:251], v[200:203], v[168:171]
    s_waitcnt lgkmcnt(8)
    v_add_f32 v140, v140, v120
    v_add_f32 v141, v141, v121
    v_mfma_f32_16x16x32_bf16 v[172:175], a[88:91], v[200:203], v[172:175]
    s_waitcnt vmcnt(3)
    v_mfma_f32_16x16x32_bf16 v[156:159], a[92:95], v[196:199], v[156:159]
    v_add_f32 v142, v142, v122
    v_add_f32 v143, v143, v123
    v_mfma_f32_16x16x32_bf16 v[160:163], a[96:99], v[196:199], v[160:163]
    s_waitcnt lgkmcnt(7)
    v_add_f32 v144, v144, v124
    v_add_f32 v145, v145, v125
    v_mfma_f32_16x16x32_bf16 v[164:167], a[100:103], v[196:199], v[164:167]
    v_add_f32 v146, v146, v126
    v_add_f32 v147, v147, v127
    v_mfma_f32_16x16x32_bf16 v[168:171], a[136:139], v[196:199], v[168:171]
    s_waitcnt lgkmcnt(6)
    v_add_f32 v148, v148, v128
    v_add_f32 v149, v149, v129
    v_mfma_f32_16x16x32_bf16 v[172:175], a[140:143], v[196:199], v[172:175]
    s_waitcnt vmcnt(2)
    v_mfma_f32_16x16x32_bf16 v[156:159], a[156:159], v[192:195], v[156:159]
    v_add_f32 v150, v150, v130
    v_add_f32 v151, v151, v131
    v_mfma_f32_16x16x32_bf16 v[160:163], a[160:163], v[192:195], v[160:163]
    s_waitcnt lgkmcnt(5)
    v_add_f32 v152, v152, v132
    v_add_f32 v153, v153, v133
    v_mfma_f32_16x16x32_bf16 v[164:167], a[192:195], v[192:195], v[164:167]
    v_add_f32 v154, v154, v134
    v_add_f32 v155, v155, v135
    v_mfma_f32_16x16x32_bf16 v[168:171], a[196:199], v[192:195], v[168:171]
    s_waitcnt lgkmcnt(4)
    v_add_f32 v136, v136, v96
    v_add_f32 v137, v137, v97
    v_mfma_f32_16x16x32_bf16 v[172:175], a[200:203], v[192:195], v[172:175]
    s_waitcnt vmcnt(1)
    v_mfma_f32_16x16x32_bf16 v[156:159], a[204:207], v[188:191], v[156:159]
    v_add_f32 v138, v138, v98
    v_add_f32 v139, v139, v99
    v_mfma_f32_16x16x32_bf16 v[160:163], a[208:211], v[188:191], v[160:163]
    s_waitcnt lgkmcnt(3)
    v_add_f32 v140, v140, v100
    v_add_f32 v141, v141, v101
    v_mfma_f32_16x16x32_bf16 v[164:167], a[212:215], v[188:191], v[164:167]
    v_add_f32 v142, v142, v102
    v_add_f32 v143, v143, v103
    v_mfma_f32_16x16x32_bf16 v[168:171], a[252:255], v[188:191], v[168:171]
    s_waitcnt lgkmcnt(2)
    v_add_f32 v144, v144, v104
    v_add_f32 v145, v145, v105
    v_mfma_f32_16x16x32_bf16 v[172:175], v[252:255], v[188:191], v[172:175]
    s_waitcnt vmcnt(0)
    v_mfma_f32_16x16x32_bf16 v[156:159], v[248:251], v[228:231], v[156:159]
    v_add_f32 v146, v146, v106
    v_add_f32 v147, v147, v107
    v_mfma_f32_16x16x32_bf16 v[160:163], v[244:247], v[228:231], v[160:163]
    s_waitcnt lgkmcnt(1)
    v_add_f32 v148, v148, v108
    v_add_f32 v149, v149, v109
    v_mfma_f32_16x16x32_bf16 v[164:167], v[240:243], v[228:231], v[164:167]
    v_add_f32 v150, v150, v110
    v_add_f32 v151, v151, v111
    v_mfma_f32_16x16x32_bf16 v[168:171], v[236:239], v[228:231], v[168:171]
    s_waitcnt lgkmcnt(0)
    v_add_f32 v152, v152, v112
    v_add_f32 v153, v153, v113
    v_mfma_f32_16x16x32_bf16 v[172:175], v[232:235], v[228:231], v[172:175]
    v_pk_add_f32 v[154:155], v[154:155], v[114:115]
    v_pk_add_f32 v[156:157], v[156:157], v[136:137]
    v_pk_add_f32 v[158:159], v[158:159], v[138:139]
    v_cvt_pk_bf16_f32 v244, v156, v157
    v_cvt_pk_bf16_f32 v245, v158, v159
    ds_write_b64 v15, v[244:245] offset:0
    v_pk_add_f32 v[160:161], v[160:161], v[140:141]
    v_pk_add_f32 v[162:163], v[162:163], v[142:143]
    v_cvt_pk_bf16_f32 v246, v160, v161
    v_cvt_pk_bf16_f32 v247, v162, v163
    ds_write_b64 v15, v[246:247] offset:8
    v_pk_add_f32 v[164:165], v[164:165], v[144:145]
    v_pk_add_f32 v[166:167], v[166:167], v[146:147]
    v_cvt_pk_bf16_f32 v248, v164, v165
    v_cvt_pk_bf16_f32 v249, v166, v167
    ds_write_b64 v15, v[248:249] offset:16
    v_pk_add_f32 v[168:169], v[168:169], v[148:149]
    v_pk_add_f32 v[170:171], v[170:171], v[150:151]
    v_cvt_pk_bf16_f32 v250, v168, v169
    v_cvt_pk_bf16_f32 v251, v170, v171
    ds_write_b64 v15, v[250:251] offset:24
    v_pk_add_f32 v[172:173], v[172:173], v[152:153]
    v_pk_add_f32 v[174:175], v[174:175], v[154:155]
    v_cvt_pk_bf16_f32 v252, v172, v173
    v_cvt_pk_bf16_f32 v253, v174, v175
    ds_write_b64 v15, v[252:253] offset:32
    ds_read_b128 v[156:159], v16
    ds_read_b128 v[160:163], v17
    ds_read_b128 v[164:167], v18
    s_waitcnt lgkmcnt(2)
    buffer_store_dwordx4 v[156:159], v19, s[56:59], s69 offen
    s_waitcnt lgkmcnt(1)
    buffer_store_dwordx4 v[160:163], v20, s[56:59], s69 offen
    s_waitcnt lgkmcnt(0)
    buffer_store_dwordx4 v[164:167], v21, s[56:59], s69 offen
L_end:
    s_endpgm
.section .rodata,"a"
.p2align 6
.amdhsa_kernel sequential_preLN__linear_kernel_hedgehog__dense_activation_squared_relu__prompt_kernel
  .amdhsa_next_free_vgpr 512
  .amdhsa_next_free_sgpr 102
  .amdhsa_accum_offset 256
  .amdhsa_group_segment_fixed_size 0
  .amdhsa_kernarg_size 96
  .amdhsa_user_sgpr_count 2
  .amdhsa_user_sgpr_kernarg_segment_ptr 1
  .amdhsa_system_sgpr_workgroup_id_x 1
.end_amdhsa_kernel
```
